```python
import torch

def _softmax(x, axis=-1):
    return torch.softmax(x, dim=axis)

def _gelu(x):
    return torch.nn.functional.gelu(x, approximate='tanh')

def _silu(x):
    return torch.nn.functional.silu(x)

def _sigmoid(x):
    return torch.sigmoid(x)

def _layernorm(x, axis=-1, eps=1e-05):
    m = x.mean(dim=axis, keepdim=True)
    v = x.var(dim=axis, keepdim=True, unbiased=False)
    return (x - m) / torch.sqrt(v + eps)

def _scatter_add(tgt, idx, src, axis=0):
    return tgt.clone().index_add_(axis, idx, src)

def _segment_sum(src, seg, n):
    out = torch.zeros((n,) + src.shape[1:], dtype=src.dtype)
    return out.index_add_(0, seg, src)

def _pad(x, pw):
    flat = tuple((v for pair in reversed(pw) for v in pair))
    return torch.nn.functional.pad(x, flat)
kernel_name = 'adaLN_cond__mha_block_cached__geglu_ffn__decode'

def setup_inputs():

    _w = lambda a: (lambda t: t.to(torch.bfloat16) if t.is_floating_point() else t)(torch.as_tensor(a))

    def _A_setup():
        B, Sq, D = (4, 1, 512)
        H, Sk, Dh = (32, 4096, 128)
        return {'x': _w((lambda *s: torch.randn(*s, dtype=torch.bfloat16) * 0.1)(B, Sq, D)), 'k_cache': _w((lambda *s: torch.randn(*s, dtype=torch.bfloat16) * 0.8)(B, H, Sk, Dh)), 'v_cache': _w((lambda *s: torch.randn(*s, dtype=torch.bfloat16) * 0.8)(B, H, Sk, Dh)), 'wq': _w((lambda *s: torch.randn(*s, dtype=torch.bfloat16) * 0.8)(D, H * Dh) * D ** (-0.5)), 'wo': _w((lambda *s: torch.randn(*s, dtype=torch.bfloat16) * 0.8)(H * Dh, D) * (H * Dh) ** (-0.5))}
    _A_in = _A_setup()

    def _B_setup():
        B, S, D, F = (4, 1, 512, 1792)
        return {'x': _w((lambda *s: torch.randn(*s, dtype=torch.bfloat16) * 0.1)(B, S, D)), 'w_gate': _w((lambda *s: torch.randn(*s, dtype=torch.bfloat16) * 0.1)(D, F)), 'w_up': _w((lambda *s: torch.randn(*s, dtype=torch.bfloat16) * 0.1)(D, F)), 'w_down': _w((lambda *s: torch.randn(*s, dtype=torch.bfloat16) * 0.1)(F, D))}
    _B_in = _B_setup()
    return {'A_x': _A_in['x'], 'A_k_cache': _A_in['k_cache'], 'A_v_cache': _A_in['v_cache'], 'A_wq': _A_in['wq'], 'A_wo': _A_in['wo'], 'B_x': _B_in['x'], 'B_w_gate': _B_in['w_gate'], 'B_w_up': _B_in['w_up'], 'B_w_down': _B_in['w_down'], 'c': _w((lambda *s: torch.randn(*s, dtype=torch.bfloat16) * 0.8)(4, 512) * 8.0), 'w_mod': _w((lambda *s: torch.randn(*s, dtype=torch.bfloat16) * 0.8)(512, 6 * 512) * 512 ** (-0.5) * 8.0)}

def reference(A_x, A_k_cache, A_v_cache, A_wq, A_wo, B_x, B_w_gate, B_w_up, B_w_down, c, w_mod):

    def _A_ref(x, k_cache, v_cache, wq, wo):
        B, Sq, D = x.shape
        H, Dh = (32, 128)
        q = (lambda x, *d: x.permute(*d))((x @ wq).reshape(B, Sq, H, Dh), 0, 2, 1, 3)
        scores = torch.einsum('bhqd,bhkd->bhqk', q, k_cache) * Dh ** (-0.5)
        p = _softmax(scores, axis=-1)
        o = torch.einsum('bhqk,bhkd->bhqd', p, v_cache)
        return (lambda x, *d: x.permute(*d))(o, 0, 2, 1, 3).reshape(B, Sq, H * Dh) @ wo

    def _B_ref(x, w_gate, w_up, w_down):
        return _gelu(x @ w_gate) * (x @ w_up) @ w_down
    x = A_x
    mod = (_silu(c) @ w_mod).reshape(c.shape[0], 6, 1, -1)
    sa, ca, ga, sb, cb, gb = (mod[:, 0].clone(), mod[:, 1].clone(), mod[:, 2].clone(), mod[:, 3].clone(), mod[:, 4].clone(), mod[:, 5].clone())
    h = _layernorm(x, axis=-1) * (1 + ca) + sa
    x = x + ga * _A_ref(h, A_k_cache, A_v_cache, A_wq, A_wo)
    h = _layernorm(x, axis=-1) * (1 + cb) + sb
    x = x + gb * _B_ref(h, B_w_gate, B_w_up, B_w_down)
    return x
```

```asm
; @launch kernel=adaln_att_kernel grid=(192,1,1) block=(1024,1,1) lds=38400
; @launch kernel=adaln_ffn_kernel grid=(56,1,1) block=(1024,1,1) lds=114688
.amdgcn_target "amdgcn-amd-amdhsa--gfx950"
.text
.globl adaln_att_kernel
.p2align 8
.type adaln_att_kernel,@function
adaln_att_kernel:
  s_cmp_ge_u32 s2, 192
  s_cbranch_scc1 L_att_end
  s_load_dwordx16 s[16:31], s[0:1], 0
  s_load_dwordx8 s[32:39], s[0:1], 64
  s_load_dwordx4 s[40:43], s[0:1], 96
  v_lshrrev_b32 v4, 6, v0
  v_and_b32 v1, 63, v0
  v_lshlrev_b32 v1, 4, v1
  v_readfirstlane_b32 s6, v4
  s_mov_b32 s50, 0x3fb8aa3b
  s_mov_b32 s51, 0x3db504f3
  s_mov_b32 s52, 0x3727c5ac
  s_cmp_lt_u32 s2, 64
  s_cbranch_scc1 L_helper
  s_sub_u32 s3, s2, 64
  s_and_b32 s7, s3, 7
  s_bfe_u32 s8, s3, 0x20003
  s_lshl_b32 s8, s8, 3
  s_add_u32 s5, s7, s8
  s_lshr_b32 s4, s3, 5
  v_and_b32 v2, 15, v0
  v_bfe_u32 v3, v0, 4, 2
  s_waitcnt lgkmcnt(0)
  s_lshl_b32 s7, s4, 5
  s_add_u32 s7, s7, s5
  s_lshl_b32 s8, s7, 20
  s_lshl_b32 s9, s6, 16
  s_add_u32 s8, s8, s9
  s_add_u32 s44, s18, s8
  s_addc_u32 s45, s19, 0
  s_add_u32 s46, s20, s8
  s_addc_u32 s47, s21, 0
  s_lshl_b32 s8, s5, 8
  s_lshl_b32 s9, s6, 18
  s_add_u32 s8, s8, s9
  s_add_u32 s48, s22, s8
  s_addc_u32 s49, s23, 0
  v_lshlrev_b32 v15, 13, v3
  v_lshlrev_b32 v4, 4, v2
  v_add_u32 v15, v15, v4
  s_lshl_b32 s8, s5, 17
  s_lshl_b32 s9, s6, 13
  s_add_u32 s8, s8, s9
  s_add_u32 s54, s24, s8
  s_addc_u32 s55, s25, 0
  s_lshl_b32 s7, s4, 10
  s_add_u32 s10, s16, s7
  s_addc_u32 s11, s17, 0
  global_load_dwordx4 v[8:11], v1, s[10:11]
  v_and_b32 v4, 12, v2
  v_add_u32 v4, v4, v3
  s_lshl_b32 s7, s6, 5
  v_add_u32 v4, s7, v4
  v_lshlrev_b32 v5, 1, v4
  global_load_ushort v12, v5, s[10:11]
  global_load_ushort v13, v5, s[10:11] offset:32
  v_lshlrev_b32 v6, 2, v4
  global_load_dwordx4 v[56:59], v15, s[48:49]
  s_add_u32 s48, s48, 32768
  s_addc_u32 s49, s49, 0
  global_load_dwordx4 v[60:63], v15, s[48:49]
  s_add_u32 s48, s48, 32768
  s_addc_u32 s49, s49, 0
  global_load_dwordx4 v[64:67], v15, s[48:49]
  s_add_u32 s48, s48, 32768
  s_addc_u32 s49, s49, 0
  global_load_dwordx4 v[68:71], v15, s[48:49]
  s_add_u32 s48, s48, 32768
  s_addc_u32 s49, s49, 0
  global_load_dwordx4 v[72:75], v15, s[48:49]
  s_add_u32 s48, s48, 32768
  s_addc_u32 s49, s49, 0
  global_load_dwordx4 v[76:79], v15, s[48:49]
  s_add_u32 s48, s48, 32768
  s_addc_u32 s49, s49, 0
  global_load_dwordx4 v[80:83], v15, s[48:49]
  s_add_u32 s48, s48, 32768
  s_addc_u32 s49, s49, 0
  global_load_dwordx4 v[84:87], v15, s[48:49]
  s_add_u32 s48, s48, 32768
  s_addc_u32 s49, s49, 0
  global_load_dwordx4 v[88:91], v1, s[44:45] offset:0 nt
  global_load_dwordx4 v[92:95], v1, s[44:45] offset:1024 nt
  global_load_dwordx4 v[96:99], v1, s[44:45] offset:2048 nt
  global_load_dwordx4 v[100:103], v1, s[44:45] offset:3072 nt
  s_add_u32 s44, s44, 4096
  s_addc_u32 s45, s45, 0
  global_load_dwordx4 v[104:107], v1, s[44:45] offset:0 nt
  global_load_dwordx4 v[108:111], v1, s[44:45] offset:1024 nt
  global_load_dwordx4 v[112:115], v1, s[44:45] offset:2048 nt
  global_load_dwordx4 v[116:119], v1, s[44:45] offset:3072 nt
  s_add_u32 s44, s44, 4096
  s_addc_u32 s45, s45, 0
  s_waitcnt vmcnt(18)
  v_lshlrev_b32 v28, 16, v8
  v_and_b32 v29, 0xffff0000, v8
  v_lshlrev_b32 v30, 16, v9
  v_and_b32 v31, 0xffff0000, v9
  v_lshlrev_b32 v32, 16, v10
  v_and_b32 v33, 0xffff0000, v10
  v_lshlrev_b32 v34, 16, v11
  v_and_b32 v35, 0xffff0000, v11
  v_add_f32 v7, v28, v29
  v_add_f32 v7, v7, v30
  v_add_f32 v7, v7, v31
  v_add_f32 v7, v7, v32
  v_add_f32 v7, v7, v33
  v_add_f32 v7, v7, v34
  v_add_f32 v7, v7, v35
  s_nop 1
  v_add_f32_dpp v7, v7, v7 row_ror:8 row_mask:0xf bank_mask:0xf
  s_nop 1
  v_add_f32_dpp v7, v7, v7 row_ror:4 row_mask:0xf bank_mask:0xf
  s_nop 1
  v_add_f32_dpp v7, v7, v7 row_ror:2 row_mask:0xf bank_mask:0xf
  s_nop 1
  v_add_f32_dpp v7, v7, v7 row_ror:1 row_mask:0xf bank_mask:0xf
  v_mov_b32 v14, v7
  s_nop 1
  v_permlane16_swap_b32 v7, v14
  v_add_f32 v7, v7, v14
  v_mov_b32 v14, v7
  s_nop 1
  v_permlane32_swap_b32 v7, v14
  v_add_f32 v7, v7, v14
  v_mul_f32 v7, 0x3b000000, v7
  v_sub_f32 v14, v28, v7
  v_mul_f32 v36, v14, v14
  v_sub_f32 v14, v29, v7
  v_fmac_f32 v36, v14, v14
  v_sub_f32 v14, v30, v7
  v_fmac_f32 v36, v14, v14
  v_sub_f32 v14, v31, v7
  v_fmac_f32 v36, v14, v14
  v_sub_f32 v14, v32, v7
  v_fmac_f32 v36, v14, v14
  v_sub_f32 v14, v33, v7
  v_fmac_f32 v36, v14, v14
  v_sub_f32 v14, v34, v7
  v_fmac_f32 v36, v14, v14
  v_sub_f32 v14, v35, v7
  v_fmac_f32 v36, v14, v14
  s_nop 1
  v_add_f32_dpp v36, v36, v36 row_ror:8 row_mask:0xf bank_mask:0xf
  s_nop 1
  v_add_f32_dpp v36, v36, v36 row_ror:4 row_mask:0xf bank_mask:0xf
  s_nop 1
  v_add_f32_dpp v36, v36, v36 row_ror:2 row_mask:0xf bank_mask:0xf
  s_nop 1
  v_add_f32_dpp v36, v36, v36 row_ror:1 row_mask:0xf bank_mask:0xf
  v_mov_b32 v14, v36
  s_nop 1
  v_permlane16_swap_b32 v36, v14
  v_add_f32 v36, v36, v14
  v_mov_b32 v14, v36
  s_nop 1
  v_permlane32_swap_b32 v36, v14
  v_add_f32 v36, v36, v14
  v_mul_f32 v36, 0x3b000000, v36
  v_cvt_pk_bf16_f32 v7, v7, v7
  v_lshlrev_b32 v7, 16, v7
  v_cvt_pk_bf16_f32 v36, v36, v36
  v_lshlrev_b32 v36, 16, v36
  v_add_f32 v36, s52, v36
  v_cvt_pk_bf16_f32 v36, v36, v36
  v_lshlrev_b32 v36, 16, v36
  v_sqrt_f32 v36, v36
  s_nop 0
  v_cvt_pk_bf16_f32 v36, v36, v36
  v_lshlrev_b32 v36, 16, v36
  v_rcp_f32 v37, v36
  s_waitcnt vmcnt(17)
  v_lshlrev_b32 v12, 16, v12
  v_sub_f32 v12, v12, v7
  v_cvt_pk_bf16_f32 v12, v12, v12
  v_lshlrev_b32 v12, 16, v12
  v_mul_f32 v14, v12, v37
  v_fma_f32 v38, -v14, v36, v12
  v_fma_f32 v14, v38, v37, v14
  v_cvt_pk_bf16_f32 v12, v14, v14
  v_lshlrev_b32 v12, 16, v12
  s_waitcnt vmcnt(16)
  v_lshlrev_b32 v13, 16, v13
  v_sub_f32 v13, v13, v7
  v_cvt_pk_bf16_f32 v13, v13, v13
  v_lshlrev_b32 v13, 16, v13
  v_mul_f32 v14, v13, v37
  v_fma_f32 v38, -v14, v36, v13
  v_fma_f32 v14, v38, v37, v14
  v_cvt_pk_bf16_f32 v13, v14, v14
  v_lshlrev_b32 v13, 16, v13
  s_cmp_lg_u32 s6, 0
  s_cbranch_scc1 L_poll_done
  s_lshl_b32 s7, s4, 2
  v_mov_b32 v14, s7
  s_mov_b32 s8, 0
  s_waitcnt vmcnt(0)
L_poll:
  s_nop 7
  global_load_dword v38, v14, s[40:41] sc1
  s_waitcnt vmcnt(0)
  v_readfirstlane_b32 s7, v38
  s_add_u32 s8, s8, 1
  s_cmp_ge_u32 s8, 400000
  s_cbranch_scc1 L_poll_done
  s_cmp_ge_u32 s7, 16
  s_cbranch_scc1 L_poll_done
  s_sleep 1
  s_branch L_poll
L_poll_done:
  s_nop 7
  s_barrier
  s_mul_i32 s7, s4, 12288
  s_add_u32 s8, s42, s7
  s_addc_u32 s9, s43, 0
  global_load_dword v28, v6, s[8:9] offset:0 sc1
  global_load_dword v29, v6, s[8:9] offset:2048 sc1
  global_load_dword v30, v6, s[8:9] offset:64 sc1
  global_load_dword v31, v6, s[8:9] offset:2112 sc1
  s_waitcnt vmcnt(2)
  v_add_f32 v29, 1.0, v29
  v_cvt_pk_bf16_f32 v29, v29, v29
  v_lshlrev_b32 v29, 16, v29
  v_mul_f32 v29, v12, v29
  v_cvt_pk_bf16_f32 v29, v29, v29
  v_lshlrev_b32 v29, 16, v29
  v_add_f32 v29, v29, v28
  v_cvt_pk_bf16_f32 v36, v29, 0
  v_lshlrev_b32 v38, 16, v36
  s_waitcnt vmcnt(0)
  v_add_f32 v31, 1.0, v31
  v_cvt_pk_bf16_f32 v31, v31, v31
  v_lshlrev_b32 v31, 16, v31
  v_mul_f32 v31, v13, v31
  v_cvt_pk_bf16_f32 v31, v31, v31
  v_lshlrev_b32 v31, 16, v31
  v_add_f32 v31, v31, v30
  v_cvt_pk_bf16_f32 v37, v31, 0
  v_lshlrev_b32 v39, 16, v37
  v_mov_b32 v20, 0
  v_mov_b32 v21, 0
  v_mov_b32 v22, 0
  v_mov_b32 v23, 0
  v_mov_b32 v24, 0
  v_mov_b32 v25, 0
  v_mov_b32 v26, 0
  v_mov_b32 v27, 0
  v_dot2c_f32_bf16_dpp v20, v36, v56 row_newbcast:0 row_mask:0xf bank_mask:0xf
  v_dot2c_f32_bf16_dpp v21, v38, v56 row_newbcast:0 row_mask:0xf bank_mask:0xf
  v_dot2c_f32_bf16_dpp v22, v36, v57 row_newbcast:0 row_mask:0xf bank_mask:0xf
  v_dot2c_f32_bf16_dpp v23, v38, v57 row_newbcast:0 row_mask:0xf bank_mask:0xf
  v_dot2c_f32_bf16_dpp v24, v36, v58 row_newbcast:0 row_mask:0xf bank_mask:0xf
  v_dot2c_f32_bf16_dpp v25, v38, v58 row_newbcast:0 row_mask:0xf bank_mask:0xf
  v_dot2c_f32_bf16_dpp v26, v36, v59 row_newbcast:0 row_mask:0xf bank_mask:0xf
  v_dot2c_f32_bf16_dpp v27, v38, v59 row_newbcast:0 row_mask:0xf bank_mask:0xf
  global_load_dwordx4 v[56:59], v1, s[44:45] offset:0 nt
  v_dot2c_f32_bf16_dpp v20, v36, v60 row_newbcast:4 row_mask:0xf bank_mask:0xf
  v_dot2c_f32_bf16_dpp v21, v38, v60 row_newbcast:4 row_mask:0xf bank_mask:0xf
  v_dot2c_f32_bf16_dpp v22, v36, v61 row_newbcast:4 row_mask:0xf bank_mask:0xf
  v_dot2c_f32_bf16_dpp v23, v38, v61 row_newbcast:4 row_mask:0xf bank_mask:0xf
  v_dot2c_f32_bf16_dpp v24, v36, v62 row_newbcast:4 row_mask:0xf bank_mask:0xf
  v_dot2c_f32_bf16_dpp v25, v38, v62 row_newbcast:4 row_mask:0xf bank_mask:0xf
  v_dot2c_f32_bf16_dpp v26, v36, v63 row_newbcast:4 row_mask:0xf bank_mask:0xf
  v_dot2c_f32_bf16_dpp v27, v38, v63 row_newbcast:4 row_mask:0xf bank_mask:0xf
  global_load_dwordx4 v[60:63], v1, s[44:45] offset:1024 nt
  v_dot2c_f32_bf16_dpp v20, v36, v64 row_newbcast:8 row_mask:0xf bank_mask:0xf
  v_dot2c_f32_bf16_dpp v21, v38, v64 row_newbcast:8 row_mask:0xf bank_mask:0xf
  v_dot2c_f32_bf16_dpp v22, v36, v65 row_newbcast:8 row_mask:0xf bank_mask:0xf
  v_dot2c_f32_bf16_dpp v23, v38, v65 row_newbcast:8 row_mask:0xf bank_mask:0xf
  v_dot2c_f32_bf16_dpp v24, v36, v66 row_newbcast:8 row_mask:0xf bank_mask:0xf
  v_dot2c_f32_bf16_dpp v25, v38, v66 row_newbcast:8 row_mask:0xf bank_mask:0xf
  v_dot2c_f32_bf16_dpp v26, v36, v67 row_newbcast:8 row_mask:0xf bank_mask:0xf
  v_dot2c_f32_bf16_dpp v27, v38, v67 row_newbcast:8 row_mask:0xf bank_mask:0xf
  global_load_dwordx4 v[64:67], v1, s[44:45] offset:2048 nt
  v_dot2c_f32_bf16_dpp v20, v36, v68 row_newbcast:12 row_mask:0xf bank_mask:0xf
  v_dot2c_f32_bf16_dpp v21, v38, v68 row_newbcast:12 row_mask:0xf bank_mask:0xf
  v_dot2c_f32_bf16_dpp v22, v36, v69 row_newbcast:12 row_mask:0xf bank_mask:0xf
  v_dot2c_f32_bf16_dpp v23, v38, v69 row_newbcast:12 row_mask:0xf bank_mask:0xf
  v_dot2c_f32_bf16_dpp v24, v36, v70 row_newbcast:12 row_mask:0xf bank_mask:0xf
  v_dot2c_f32_bf16_dpp v25, v38, v70 row_newbcast:12 row_mask:0xf bank_mask:0xf
  v_dot2c_f32_bf16_dpp v26, v36, v71 row_newbcast:12 row_mask:0xf bank_mask:0xf
  v_dot2c_f32_bf16_dpp v27, v38, v71 row_newbcast:12 row_mask:0xf bank_mask:0xf
  global_load_dwordx4 v[68:71], v1, s[44:45] offset:3072 nt
  s_add_u32 s44, s44, 4096
  s_addc_u32 s45, s45, 0
  v_dot2c_f32_bf16_dpp v20, v37, v72 row_newbcast:0 row_mask:0xf bank_mask:0xf
  v_dot2c_f32_bf16_dpp v21, v39, v72 row_newbcast:0 row_mask:0xf bank_mask:0xf
  v_dot2c_f32_bf16_dpp v22, v37, v73 row_newbcast:0 row_mask:0xf bank_mask:0xf
  v_dot2c_f32_bf16_dpp v23, v39, v73 row_newbcast:0 row_mask:0xf bank_mask:0xf
  v_dot2c_f32_bf16_dpp v24, v37, v74 row_newbcast:0 row_mask:0xf bank_mask:0xf
  v_dot2c_f32_bf16_dpp v25, v39, v74 row_newbcast:0 row_mask:0xf bank_mask:0xf
  v_dot2c_f32_bf16_dpp v26, v37, v75 row_newbcast:0 row_mask:0xf bank_mask:0xf
  v_dot2c_f32_bf16_dpp v27, v39, v75 row_newbcast:0 row_mask:0xf bank_mask:0xf
  global_load_dwordx4 v[72:75], v1, s[44:45] offset:0 nt
  v_dot2c_f32_bf16_dpp v20, v37, v76 row_newbcast:4 row_mask:0xf bank_mask:0xf
  v_dot2c_f32_bf16_dpp v21, v39, v76 row_newbcast:4 row_mask:0xf bank_mask:0xf
  v_dot2c_f32_bf16_dpp v22, v37, v77 row_newbcast:4 row_mask:0xf bank_mask:0xf
  v_dot2c_f32_bf16_dpp v23, v39, v77 row_newbcast:4 row_mask:0xf bank_mask:0xf
  v_dot2c_f32_bf16_dpp v24, v37, v78 row_newbcast:4 row_mask:0xf bank_mask:0xf
  v_dot2c_f32_bf16_dpp v25, v39, v78 row_newbcast:4 row_mask:0xf bank_mask:0xf
  v_dot2c_f32_bf16_dpp v26, v37, v79 row_newbcast:4 row_mask:0xf bank_mask:0xf
  v_dot2c_f32_bf16_dpp v27, v39, v79 row_newbcast:4 row_mask:0xf bank_mask:0xf
  global_load_dwordx4 v[76:79], v1, s[44:45] offset:1024 nt
  v_dot2c_f32_bf16_dpp v20, v37, v80 row_newbcast:8 row_mask:0xf bank_mask:0xf
  v_dot2c_f32_bf16_dpp v21, v39, v80 row_newbcast:8 row_mask:0xf bank_mask:0xf
  v_dot2c_f32_bf16_dpp v22, v37, v81 row_newbcast:8 row_mask:0xf bank_mask:0xf
  v_dot2c_f32_bf16_dpp v23, v39, v81 row_newbcast:8 row_mask:0xf bank_mask:0xf
  v_dot2c_f32_bf16_dpp v24, v37, v82 row_newbcast:8 row_mask:0xf bank_mask:0xf
  v_dot2c_f32_bf16_dpp v25, v39, v82 row_newbcast:8 row_mask:0xf bank_mask:0xf
  v_dot2c_f32_bf16_dpp v26, v37, v83 row_newbcast:8 row_mask:0xf bank_mask:0xf
  v_dot2c_f32_bf16_dpp v27, v39, v83 row_newbcast:8 row_mask:0xf bank_mask:0xf
  global_load_dwordx4 v[80:83], v1, s[44:45] offset:2048 nt
  v_dot2c_f32_bf16_dpp v20, v37, v84 row_newbcast:12 row_mask:0xf bank_mask:0xf
  v_dot2c_f32_bf16_dpp v21, v39, v84 row_newbcast:12 row_mask:0xf bank_mask:0xf
  v_dot2c_f32_bf16_dpp v22, v37, v85 row_newbcast:12 row_mask:0xf bank_mask:0xf
  v_dot2c_f32_bf16_dpp v23, v39, v85 row_newbcast:12 row_mask:0xf bank_mask:0xf
  v_dot2c_f32_bf16_dpp v24, v37, v86 row_newbcast:12 row_mask:0xf bank_mask:0xf
  v_dot2c_f32_bf16_dpp v25, v39, v86 row_newbcast:12 row_mask:0xf bank_mask:0xf
  v_dot2c_f32_bf16_dpp v26, v37, v87 row_newbcast:12 row_mask:0xf bank_mask:0xf
  v_dot2c_f32_bf16_dpp v27, v39, v87 row_newbcast:12 row_mask:0xf bank_mask:0xf
  global_load_dwordx4 v[84:87], v1, s[44:45] offset:3072 nt
  s_add_u32 s44, s44, 4096
  s_addc_u32 s45, s45, 0
  s_lshl_b32 s7, s6, 11
  v_lshlrev_b32 v14, 9, v3
  v_lshlrev_b32 v13, 5, v2
  v_add_u32 v14, v14, v13
  v_add_u32 v14, s7, v14
  ds_write_b128 v14, v[20:23] offset:0
  ds_write_b128 v14, v[24:27] offset:16
  s_waitcnt lgkmcnt(0)
  s_barrier
  v_and_b32 v13, 127, v0
  v_lshlrev_b32 v13, 2, v13
  v_lshrrev_b32 v14, 7, v0
  v_lshlrev_b32 v12, 12, v14
  v_add_u32 v12, v12, v13
  ds_read_b32 v28, v12 offset:0
  ds_read_b32 v29, v12 offset:512
  ds_read_b32 v30, v12 offset:1024
  ds_read_b32 v31, v12 offset:1536
  ds_read_b32 v32, v12 offset:2048
  ds_read_b32 v33, v12 offset:2560
  ds_read_b32 v34, v12 offset:3072
  ds_read_b32 v35, v12 offset:3584
  s_waitcnt lgkmcnt(6)
  v_add_f32 v8, v28, v29
  s_waitcnt lgkmcnt(5)
  v_add_f32 v8, v8, v30
  s_waitcnt lgkmcnt(4)
  v_add_f32 v8, v8, v31
  s_waitcnt lgkmcnt(3)
  v_add_f32 v8, v8, v32
  s_waitcnt lgkmcnt(2)
  v_add_f32 v8, v8, v33
  s_waitcnt lgkmcnt(1)
  v_add_f32 v8, v8, v34
  s_waitcnt lgkmcnt(0)
  v_add_f32 v8, v8, v35
  v_lshlrev_b32 v12, 9, v14
  v_add_u32 v12, v12, v13
  ds_write_b32 v12, v8 offset:32768
  s_waitcnt lgkmcnt(0)
  s_barrier
  s_cmp_ge_u32 s6, 2
  s_cbranch_scc1 L_red_skip_q
  ds_read_b32 v28, v13 offset:32768
  ds_read_b32 v29, v13 offset:33280
  ds_read_b32 v30, v13 offset:33792
  ds_read_b32 v31, v13 offset:34304
  ds_read_b32 v32, v13 offset:34816
  ds_read_b32 v33, v13 offset:35328
  ds_read_b32 v34, v13 offset:35840
  ds_read_b32 v35, v13 offset:36352
  s_waitcnt lgkmcnt(6)
  v_add_f32 v8, v28, v29
  s_waitcnt lgkmcnt(5)
  v_add_f32 v8, v8, v30
  s_waitcnt lgkmcnt(4)
  v_add_f32 v8, v8, v31
  s_waitcnt lgkmcnt(3)
  v_add_f32 v8, v8, v32
  s_waitcnt lgkmcnt(2)
  v_add_f32 v8, v8, v33
  s_waitcnt lgkmcnt(1)
  v_add_f32 v8, v8, v34
  s_waitcnt lgkmcnt(0)
  v_add_f32 v8, v8, v35
  v_cvt_pk_bf16_f32 v8, v8, 0
  v_lshrrev_b32 v12, 1, v13
  ds_write_b16 v12, v8 offset:36864
L_red_skip_q:
  s_nop 7
  s_waitcnt lgkmcnt(0)
  s_barrier
  v_lshlrev_b32 v12, 4, v2
  ds_read_b128 v[16:19], v12 offset:36864
  s_waitcnt lgkmcnt(0)
  v_dot2_f32_bf16 v28, v88, v16, 0
  s_nop 2
  v_dot2_f32_bf16 v28, v89, v17, v28
  s_nop 2
  v_dot2_f32_bf16 v28, v90, v18, v28
  s_nop 2
  v_dot2_f32_bf16 v28, v91, v19, v28
  global_load_dwordx4 v[88:91], v1, s[44:45] offset:0 nt
  v_dot2_f32_bf16 v29, v92, v16, 0
  s_nop 2
  v_dot2_f32_bf16 v29, v93, v17, v29
  s_nop 2
  v_dot2_f32_bf16 v29, v94, v18, v29
  s_nop 2
  v_dot2_f32_bf16 v29, v95, v19, v29
  global_load_dwordx4 v[92:95], v1, s[44:45] offset:1024 nt
  v_dot2_f32_bf16 v30, v96, v16, 0
  s_nop 2
  v_dot2_f32_bf16 v30, v97, v17, v30
  s_nop 2
  v_dot2_f32_bf16 v30, v98, v18, v30
  s_nop 2
  v_dot2_f32_bf16 v30, v99, v19, v30
  global_load_dwordx4 v[96:99], v1, s[44:45] offset:2048 nt
  v_dot2_f32_bf16 v31, v100, v16, 0
  s_nop 2
  v_dot2_f32_bf16 v31, v101, v17, v31
  s_nop 2
  v_dot2_f32_bf16 v31, v102, v18, v31
  s_nop 2
  v_dot2_f32_bf16 v31, v103, v19, v31
  global_load_dwordx4 v[100:103], v1, s[44:45] offset:3072 nt
  s_add_u32 s44, s44, 4096
  s_addc_u32 s45, s45, 0
  v_dot2_f32_bf16 v32, v104, v16, 0
  s_nop 2
  v_dot2_f32_bf16 v32, v105, v17, v32
  s_nop 2
  v_dot2_f32_bf16 v32, v106, v18, v32
  s_nop 2
  v_dot2_f32_bf16 v32, v107, v19, v32
  global_load_dwordx4 v[104:107], v1, s[44:45] offset:0 nt
  v_add_f32_dpp v28, v28, v28 row_ror:8 row_mask:0xf bank_mask:0xf
  v_add_f32_dpp v30, v30, v30 row_ror:8 row_mask:0xf bank_mask:0xf
  v_dot2_f32_bf16 v33, v108, v16, 0
  s_nop 2
  v_dot2_f32_bf16 v33, v109, v17, v33
  s_nop 2
  v_dot2_f32_bf16 v33, v110, v18, v33
  s_nop 2
  v_dot2_f32_bf16 v33, v111, v19, v33
  global_load_dwordx4 v[108:111], v1, s[44:45] offset:1024 nt
  v_add_f32_dpp v28, v29, v29 row_ror:8 row_mask:0xf bank_mask:0xc
  v_add_f32_dpp v30, v31, v31 row_ror:8 row_mask:0xf bank_mask:0xc
  v_dot2_f32_bf16 v34, v112, v16, 0
  s_nop 2
  v_dot2_f32_bf16 v34, v113, v17, v34
  s_nop 2
  v_dot2_f32_bf16 v34, v114, v18, v34
  s_nop 2
  v_dot2_f32_bf16 v34, v115, v19, v34
  global_load_dwordx4 v[112:115], v1, s[44:45] offset:2048 nt
  v_add_f32_dpp v28, v28, v28 row_ror:12 row_mask:0xf bank_mask:0xf
  s_nop 1
  v_add_f32_dpp v28, v30, v30 row_ror:4 row_mask:0xf bank_mask:0xa
  v_dot2_f32_bf16 v35, v116, v16, 0
  s_nop 2
  v_dot2_f32_bf16 v35, v117, v17, v35
  s_nop 2
  v_dot2_f32_bf16 v35, v118, v18, v35
  s_nop 2
  v_dot2_f32_bf16 v35, v119, v19, v35
  global_load_dwordx4 v[116:119], v1, s[44:45] offset:3072 nt
  s_add_u32 s44, s44, 4096
  s_addc_u32 s45, s45, 0
  v_add_f32_dpp v28, v28, v28 quad_perm:[2,3,0,1] row_mask:0xf bank_mask:0xf
  s_nop 1
  v_add_f32_dpp v36, v28, v28 quad_perm:[1,0,3,2] row_mask:0xf bank_mask:0xf bound_ctrl:0
  s_waitcnt vmcnt(15)
  v_dot2_f32_bf16 v28, v56, v16, 0
  s_nop 2
  v_dot2_f32_bf16 v28, v57, v17, v28
  s_nop 2
  v_dot2_f32_bf16 v28, v58, v18, v28
  s_nop 2
  v_dot2_f32_bf16 v28, v59, v19, v28
  global_load_dwordx4 v[56:59], v1, s[44:45] offset:0 nt
  v_add_f32_dpp v32, v32, v32 row_ror:8 row_mask:0xf bank_mask:0xf
  v_add_f32_dpp v34, v34, v34 row_ror:8 row_mask:0xf bank_mask:0xf
  s_waitcnt vmcnt(15)
  v_dot2_f32_bf16 v29, v60, v16, 0
  s_nop 2
  v_dot2_f32_bf16 v29, v61, v17, v29
  s_nop 2
  v_dot2_f32_bf16 v29, v62, v18, v29
  s_nop 2
  v_dot2_f32_bf16 v29, v63, v19, v29
  global_load_dwordx4 v[60:63], v1, s[44:45] offset:1024 nt
  v_add_f32_dpp v32, v33, v33 row_ror:8 row_mask:0xf bank_mask:0xc
  v_add_f32_dpp v34, v35, v35 row_ror:8 row_mask:0xf bank_mask:0xc
  s_waitcnt vmcnt(15)
  v_dot2_f32_bf16 v30, v64, v16, 0
  s_nop 2
  v_dot2_f32_bf16 v30, v65, v17, v30
  s_nop 2
  v_dot2_f32_bf16 v30, v66, v18, v30
  s_nop 2
  v_dot2_f32_bf16 v30, v67, v19, v30
  global_load_dwordx4 v[64:67], v1, s[44:45] offset:2048 nt
  v_add_f32_dpp v32, v32, v32 row_ror:12 row_mask:0xf bank_mask:0xf
  s_nop 1
  v_add_f32_dpp v32, v34, v34 row_ror:4 row_mask:0xf bank_mask:0xa
  s_waitcnt vmcnt(15)
  v_dot2_f32_bf16 v31, v68, v16, 0
  s_nop 2
  v_dot2_f32_bf16 v31, v69, v17, v31
  s_nop 2
  v_dot2_f32_bf16 v31, v70, v18, v31
  s_nop 2
  v_dot2_f32_bf16 v31, v71, v19, v31
  global_load_dwordx4 v[68:71], v1, s[44:45] offset:3072 nt
  s_add_u32 s44, s44, 4096
  s_addc_u32 s45, s45, 0
  v_add_f32_dpp v32, v32, v32 quad_perm:[2,3,0,1] row_mask:0xf bank_mask:0xf
  s_nop 1
  v_add_f32_dpp v37, v32, v32 quad_perm:[1,0,3,2] row_mask:0xf bank_mask:0xf bound_ctrl:0
  s_waitcnt vmcnt(15)
  v_dot2_f32_bf16 v32, v72, v16, 0
  s_nop 2
  v_dot2_f32_bf16 v32, v73, v17, v32
  s_nop 2
  v_dot2_f32_bf16 v32, v74, v18, v32
  s_nop 2
  v_dot2_f32_bf16 v32, v75, v19, v32
  global_load_dwordx4 v[72:75], v1, s[44:45] offset:0 nt
  v_add_f32_dpp v28, v28, v28 row_ror:8 row_mask:0xf bank_mask:0xf
  v_add_f32_dpp v30, v30, v30 row_ror:8 row_mask:0xf bank_mask:0xf
  s_waitcnt vmcnt(15)
  v_dot2_f32_bf16 v33, v76, v16, 0
  s_nop 2
  v_dot2_f32_bf16 v33, v77, v17, v33
  s_nop 2
  v_dot2_f32_bf16 v33, v78, v18, v33
  s_nop 2
  v_dot2_f32_bf16 v33, v79, v19, v33
  global_load_dwordx4 v[76:79], v1, s[44:45] offset:1024 nt
  v_add_f32_dpp v28, v29, v29 row_ror:8 row_mask:0xf bank_mask:0xc
  v_add_f32_dpp v30, v31, v31 row_ror:8 row_mask:0xf bank_mask:0xc
  s_waitcnt vmcnt(15)
  v_dot2_f32_bf16 v34, v80, v16, 0
  s_nop 2
  v_dot2_f32_bf16 v34, v81, v17, v34
  s_nop 2
  v_dot2_f32_bf16 v34, v82, v18, v34
  s_nop 2
  v_dot2_f32_bf16 v34, v83, v19, v34
  global_load_dwordx4 v[80:83], v1, s[44:45] offset:2048 nt
  v_add_f32_dpp v28, v28, v28 row_ror:12 row_mask:0xf bank_mask:0xf
  s_nop 1
  v_add_f32_dpp v28, v30, v30 row_ror:4 row_mask:0xf bank_mask:0xa
  s_waitcnt vmcnt(15)
  v_dot2_f32_bf16 v35, v84, v16, 0
  s_nop 2
  v_dot2_f32_bf16 v35, v85, v17, v35
  s_nop 2
  v_dot2_f32_bf16 v35, v86, v18, v35
  s_nop 2
  v_dot2_f32_bf16 v35, v87, v19, v35
  global_load_dwordx4 v[84:87], v1, s[44:45] offset:3072 nt
  s_add_u32 s44, s44, 4096
  s_addc_u32 s45, s45, 0
  v_add_f32_dpp v28, v28, v28 quad_perm:[2,3,0,1] row_mask:0xf bank_mask:0xf
  s_nop 1
  v_add_f32_dpp v38, v28, v28 quad_perm:[1,0,3,2] row_mask:0xf bank_mask:0xf bound_ctrl:0
  s_waitcnt vmcnt(15)
  v_dot2_f32_bf16 v28, v88, v16, 0
  s_nop 2
  v_dot2_f32_bf16 v28, v89, v17, v28
  s_nop 2
  v_dot2_f32_bf16 v28, v90, v18, v28
  s_nop 2
  v_dot2_f32_bf16 v28, v91, v19, v28
  global_load_dwordx4 v[88:91], v1, s[44:45] offset:0 nt
  v_add_f32_dpp v32, v32, v32 row_ror:8 row_mask:0xf bank_mask:0xf
  v_add_f32_dpp v34, v34, v34 row_ror:8 row_mask:0xf bank_mask:0xf
  s_waitcnt vmcnt(15)
  v_dot2_f32_bf16 v29, v92, v16, 0
  s_nop 2
  v_dot2_f32_bf16 v29, v93, v17, v29
  s_nop 2
  v_dot2_f32_bf16 v29, v94, v18, v29
  s_nop 2
  v_dot2_f32_bf16 v29, v95, v19, v29
  global_load_dwordx4 v[92:95], v1, s[44:45] offset:1024 nt
  v_add_f32_dpp v32, v33, v33 row_ror:8 row_mask:0xf bank_mask:0xc
  v_add_f32_dpp v34, v35, v35 row_ror:8 row_mask:0xf bank_mask:0xc
  s_waitcnt vmcnt(15)
  v_dot2_f32_bf16 v30, v96, v16, 0
  s_nop 2
  v_dot2_f32_bf16 v30, v97, v17, v30
  s_nop 2
  v_dot2_f32_bf16 v30, v98, v18, v30
  s_nop 2
  v_dot2_f32_bf16 v30, v99, v19, v30
  global_load_dwordx4 v[96:99], v1, s[44:45] offset:2048 nt
  v_add_f32_dpp v32, v32, v32 row_ror:12 row_mask:0xf bank_mask:0xf
  s_nop 1
  v_add_f32_dpp v32, v34, v34 row_ror:4 row_mask:0xf bank_mask:0xa
  s_waitcnt vmcnt(15)
  v_dot2_f32_bf16 v31, v100, v16, 0
  s_nop 2
  v_dot2_f32_bf16 v31, v101, v17, v31
  s_nop 2
  v_dot2_f32_bf16 v31, v102, v18, v31
  s_nop 2
  v_dot2_f32_bf16 v31, v103, v19, v31
  global_load_dwordx4 v[100:103], v1, s[44:45] offset:3072 nt
  s_add_u32 s44, s44, 4096
  s_addc_u32 s45, s45, 0
  v_add_f32_dpp v32, v32, v32 quad_perm:[2,3,0,1] row_mask:0xf bank_mask:0xf
  s_nop 1
  v_add_f32_dpp v39, v32, v32 quad_perm:[1,0,3,2] row_mask:0xf bank_mask:0xf bound_ctrl:0
  s_waitcnt vmcnt(15)
  v_dot2_f32_bf16 v32, v104, v16, 0
  s_nop 2
  v_dot2_f32_bf16 v32, v105, v17, v32
  s_nop 2
  v_dot2_f32_bf16 v32, v106, v18, v32
  s_nop 2
  v_dot2_f32_bf16 v32, v107, v19, v32
  global_load_dwordx4 v[104:107], v1, s[44:45] offset:0 nt
  v_add_f32_dpp v28, v28, v28 row_ror:8 row_mask:0xf bank_mask:0xf
  v_add_f32_dpp v30, v30, v30 row_ror:8 row_mask:0xf bank_mask:0xf
  s_waitcnt vmcnt(15)
  v_dot2_f32_bf16 v33, v108, v16, 0
  s_nop 2
  v_dot2_f32_bf16 v33, v109, v17, v33
  s_nop 2
  v_dot2_f32_bf16 v33, v110, v18, v33
  s_nop 2
  v_dot2_f32_bf16 v33, v111, v19, v33
  global_load_dwordx4 v[108:111], v1, s[44:45] offset:1024 nt
  v_add_f32_dpp v28, v29, v29 row_ror:8 row_mask:0xf bank_mask:0xc
  v_add_f32_dpp v30, v31, v31 row_ror:8 row_mask:0xf bank_mask:0xc
  s_waitcnt vmcnt(15)
  v_dot2_f32_bf16 v34, v112, v16, 0
  s_nop 2
  v_dot2_f32_bf16 v34, v113, v17, v34
  s_nop 2
  v_dot2_f32_bf16 v34, v114, v18, v34
  s_nop 2
  v_dot2_f32_bf16 v34, v115, v19, v34
  global_load_dwordx4 v[112:115], v1, s[44:45] offset:2048 nt
  v_add_f32_dpp v28, v28, v28 row_ror:12 row_mask:0xf bank_mask:0xf
  s_nop 1
  v_add_f32_dpp v28, v30, v30 row_ror:4 row_mask:0xf bank_mask:0xa
  s_waitcnt vmcnt(15)
  v_dot2_f32_bf16 v35, v116, v16, 0
  s_nop 2
  v_dot2_f32_bf16 v35, v117, v17, v35
  s_nop 2
  v_dot2_f32_bf16 v35, v118, v18, v35
  s_nop 2
  v_dot2_f32_bf16 v35, v119, v19, v35
  global_load_dwordx4 v[116:119], v1, s[44:45] offset:3072 nt
  s_add_u32 s44, s44, 4096
  s_addc_u32 s45, s45, 0
  v_add_f32_dpp v28, v28, v28 quad_perm:[2,3,0,1] row_mask:0xf bank_mask:0xf
  s_nop 1
  v_add_f32_dpp v40, v28, v28 quad_perm:[1,0,3,2] row_mask:0xf bank_mask:0xf bound_ctrl:0
  s_waitcnt vmcnt(15)
  v_dot2_f32_bf16 v28, v56, v16, 0
  s_nop 2
  v_dot2_f32_bf16 v28, v57, v17, v28
  s_nop 2
  v_dot2_f32_bf16 v28, v58, v18, v28
  s_nop 2
  v_dot2_f32_bf16 v28, v59, v19, v28
  global_load_dwordx4 v[56:59], v1, s[44:45] offset:0 nt
  v_add_f32_dpp v32, v32, v32 row_ror:8 row_mask:0xf bank_mask:0xf
  v_add_f32_dpp v34, v34, v34 row_ror:8 row_mask:0xf bank_mask:0xf
  s_waitcnt vmcnt(15)
  v_dot2_f32_bf16 v29, v60, v16, 0
  s_nop 2
  v_dot2_f32_bf16 v29, v61, v17, v29
  s_nop 2
  v_dot2_f32_bf16 v29, v62, v18, v29
  s_nop 2
  v_dot2_f32_bf16 v29, v63, v19, v29
  global_load_dwordx4 v[60:63], v1, s[44:45] offset:1024 nt
  v_add_f32_dpp v32, v33, v33 row_ror:8 row_mask:0xf bank_mask:0xc
  v_add_f32_dpp v34, v35, v35 row_ror:8 row_mask:0xf bank_mask:0xc
  s_waitcnt vmcnt(15)
  v_dot2_f32_bf16 v30, v64, v16, 0
  s_nop 2
  v_dot2_f32_bf16 v30, v65, v17, v30
  s_nop 2
  v_dot2_f32_bf16 v30, v66, v18, v30
  s_nop 2
  v_dot2_f32_bf16 v30, v67, v19, v30
  global_load_dwordx4 v[64:67], v1, s[44:45] offset:2048 nt
  v_add_f32_dpp v32, v32, v32 row_ror:12 row_mask:0xf bank_mask:0xf
  s_nop 1
  v_add_f32_dpp v32, v34, v34 row_ror:4 row_mask:0xf bank_mask:0xa
  s_waitcnt vmcnt(15)
  v_dot2_f32_bf16 v31, v68, v16, 0
  s_nop 2
  v_dot2_f32_bf16 v31, v69, v17, v31
  s_nop 2
  v_dot2_f32_bf16 v31, v70, v18, v31
  s_nop 2
  v_dot2_f32_bf16 v31, v71, v19, v31
  global_load_dwordx4 v[68:71], v1, s[44:45] offset:3072 nt
  s_add_u32 s44, s44, 4096
  s_addc_u32 s45, s45, 0
  v_add_f32_dpp v32, v32, v32 quad_perm:[2,3,0,1] row_mask:0xf bank_mask:0xf
  s_nop 1
  v_add_f32_dpp v41, v32, v32 quad_perm:[1,0,3,2] row_mask:0xf bank_mask:0xf bound_ctrl:0
  s_waitcnt vmcnt(15)
  v_dot2_f32_bf16 v32, v72, v16, 0
  s_nop 2
  v_dot2_f32_bf16 v32, v73, v17, v32
  s_nop 2
  v_dot2_f32_bf16 v32, v74, v18, v32
  s_nop 2
  v_dot2_f32_bf16 v32, v75, v19, v32
  global_load_dwordx4 v[72:75], v1, s[44:45] offset:0 nt
  v_add_f32_dpp v28, v28, v28 row_ror:8 row_mask:0xf bank_mask:0xf
  v_add_f32_dpp v30, v30, v30 row_ror:8 row_mask:0xf bank_mask:0xf
  s_waitcnt vmcnt(15)
  v_dot2_f32_bf16 v33, v76, v16, 0
  s_nop 2
  v_dot2_f32_bf16 v33, v77, v17, v33
  s_nop 2
  v_dot2_f32_bf16 v33, v78, v18, v33
  s_nop 2
  v_dot2_f32_bf16 v33, v79, v19, v33
  global_load_dwordx4 v[76:79], v1, s[44:45] offset:1024 nt
  v_add_f32_dpp v28, v29, v29 row_ror:8 row_mask:0xf bank_mask:0xc
  v_add_f32_dpp v30, v31, v31 row_ror:8 row_mask:0xf bank_mask:0xc
  s_waitcnt vmcnt(15)
  v_dot2_f32_bf16 v34, v80, v16, 0
  s_nop 2
  v_dot2_f32_bf16 v34, v81, v17, v34
  s_nop 2
  v_dot2_f32_bf16 v34, v82, v18, v34
  s_nop 2
  v_dot2_f32_bf16 v34, v83, v19, v34
  global_load_dwordx4 v[80:83], v1, s[44:45] offset:2048 nt
  v_add_f32_dpp v28, v28, v28 row_ror:12 row_mask:0xf bank_mask:0xf
  s_nop 1
  v_add_f32_dpp v28, v30, v30 row_ror:4 row_mask:0xf bank_mask:0xa
  s_waitcnt vmcnt(15)
  v_dot2_f32_bf16 v35, v84, v16, 0
  s_nop 2
  v_dot2_f32_bf16 v35, v85, v17, v35
  s_nop 2
  v_dot2_f32_bf16 v35, v86, v18, v35
  s_nop 2
  v_dot2_f32_bf16 v35, v87, v19, v35
  global_load_dwordx4 v[84:87], v1, s[44:45] offset:3072 nt
  s_add_u32 s44, s44, 4096
  s_addc_u32 s45, s45, 0
  v_add_f32_dpp v28, v28, v28 quad_perm:[2,3,0,1] row_mask:0xf bank_mask:0xf
  s_nop 1
  v_add_f32_dpp v42, v28, v28 quad_perm:[1,0,3,2] row_mask:0xf bank_mask:0xf bound_ctrl:0
  s_waitcnt vmcnt(15)
  v_dot2_f32_bf16 v28, v88, v16, 0
  s_nop 2
  v_dot2_f32_bf16 v28, v89, v17, v28
  s_nop 2
  v_dot2_f32_bf16 v28, v90, v18, v28
  s_nop 2
  v_dot2_f32_bf16 v28, v91, v19, v28
  global_load_dwordx4 v[88:91], v1, s[44:45] offset:0 nt
  v_add_f32_dpp v32, v32, v32 row_ror:8 row_mask:0xf bank_mask:0xf
  v_add_f32_dpp v34, v34, v34 row_ror:8 row_mask:0xf bank_mask:0xf
  s_waitcnt vmcnt(15)
  v_dot2_f32_bf16 v29, v92, v16, 0
  s_nop 2
  v_dot2_f32_bf16 v29, v93, v17, v29
  s_nop 2
  v_dot2_f32_bf16 v29, v94, v18, v29
  s_nop 2
  v_dot2_f32_bf16 v29, v95, v19, v29
  global_load_dwordx4 v[92:95], v1, s[44:45] offset:1024 nt
  v_add_f32_dpp v32, v33, v33 row_ror:8 row_mask:0xf bank_mask:0xc
  v_add_f32_dpp v34, v35, v35 row_ror:8 row_mask:0xf bank_mask:0xc
  s_waitcnt vmcnt(15)
  v_dot2_f32_bf16 v30, v96, v16, 0
  s_nop 2
  v_dot2_f32_bf16 v30, v97, v17, v30
  s_nop 2
  v_dot2_f32_bf16 v30, v98, v18, v30
  s_nop 2
  v_dot2_f32_bf16 v30, v99, v19, v30
  global_load_dwordx4 v[96:99], v1, s[44:45] offset:2048 nt
  v_add_f32_dpp v32, v32, v32 row_ror:12 row_mask:0xf bank_mask:0xf
  s_nop 1
  v_add_f32_dpp v32, v34, v34 row_ror:4 row_mask:0xf bank_mask:0xa
  s_waitcnt vmcnt(15)
  v_dot2_f32_bf16 v31, v100, v16, 0
  s_nop 2
  v_dot2_f32_bf16 v31, v101, v17, v31
  s_nop 2
  v_dot2_f32_bf16 v31, v102, v18, v31
  s_nop 2
  v_dot2_f32_bf16 v31, v103, v19, v31
  global_load_dwordx4 v[100:103], v1, s[44:45] offset:3072 nt
  s_add_u32 s44, s44, 4096
  s_addc_u32 s45, s45, 0
  v_add_f32_dpp v32, v32, v32 quad_perm:[2,3,0,1] row_mask:0xf bank_mask:0xf
  s_nop 1
  v_add_f32_dpp v43, v32, v32 quad_perm:[1,0,3,2] row_mask:0xf bank_mask:0xf bound_ctrl:0
  s_waitcnt vmcnt(15)
  v_dot2_f32_bf16 v32, v104, v16, 0
  s_nop 2
  v_dot2_f32_bf16 v32, v105, v17, v32
  s_nop 2
  v_dot2_f32_bf16 v32, v106, v18, v32
  s_nop 2
  v_dot2_f32_bf16 v32, v107, v19, v32
  global_load_dwordx4 v[104:107], v1, s[44:45] offset:0 nt
  v_add_f32_dpp v28, v28, v28 row_ror:8 row_mask:0xf bank_mask:0xf
  v_add_f32_dpp v30, v30, v30 row_ror:8 row_mask:0xf bank_mask:0xf
  s_waitcnt vmcnt(15)
  v_dot2_f32_bf16 v33, v108, v16, 0
  s_nop 2
  v_dot2_f32_bf16 v33, v109, v17, v33
  s_nop 2
  v_dot2_f32_bf16 v33, v110, v18, v33
  s_nop 2
  v_dot2_f32_bf16 v33, v111, v19, v33
  global_load_dwordx4 v[108:111], v1, s[44:45] offset:1024 nt
  v_add_f32_dpp v28, v29, v29 row_ror:8 row_mask:0xf bank_mask:0xc
  v_add_f32_dpp v30, v31, v31 row_ror:8 row_mask:0xf bank_mask:0xc
  s_waitcnt vmcnt(15)
  v_dot2_f32_bf16 v34, v112, v16, 0
  s_nop 2
  v_dot2_f32_bf16 v34, v113, v17, v34
  s_nop 2
  v_dot2_f32_bf16 v34, v114, v18, v34
  s_nop 2
  v_dot2_f32_bf16 v34, v115, v19, v34
  global_load_dwordx4 v[112:115], v1, s[44:45] offset:2048 nt
  v_add_f32_dpp v28, v28, v28 row_ror:12 row_mask:0xf bank_mask:0xf
  s_nop 1
  v_add_f32_dpp v28, v30, v30 row_ror:4 row_mask:0xf bank_mask:0xa
  s_waitcnt vmcnt(15)
  v_dot2_f32_bf16 v35, v116, v16, 0
  s_nop 2
  v_dot2_f32_bf16 v35, v117, v17, v35
  s_nop 2
  v_dot2_f32_bf16 v35, v118, v18, v35
  s_nop 2
  v_dot2_f32_bf16 v35, v119, v19, v35
  global_load_dwordx4 v[116:119], v1, s[44:45] offset:3072 nt
  s_add_u32 s44, s44, 4096
  s_addc_u32 s45, s45, 0
  v_add_f32_dpp v28, v28, v28 quad_perm:[2,3,0,1] row_mask:0xf bank_mask:0xf
  s_nop 1
  v_add_f32_dpp v44, v28, v28 quad_perm:[1,0,3,2] row_mask:0xf bank_mask:0xf bound_ctrl:0
  s_waitcnt vmcnt(15)
  v_dot2_f32_bf16 v28, v56, v16, 0
  s_nop 2
  v_dot2_f32_bf16 v28, v57, v17, v28
  s_nop 2
  v_dot2_f32_bf16 v28, v58, v18, v28
  s_nop 2
  v_dot2_f32_bf16 v28, v59, v19, v28
  global_load_dwordx4 v[56:59], v1, s[44:45] offset:0 nt
  v_add_f32_dpp v32, v32, v32 row_ror:8 row_mask:0xf bank_mask:0xf
  v_add_f32_dpp v34, v34, v34 row_ror:8 row_mask:0xf bank_mask:0xf
  s_waitcnt vmcnt(15)
  v_dot2_f32_bf16 v29, v60, v16, 0
  s_nop 2
  v_dot2_f32_bf16 v29, v61, v17, v29
  s_nop 2
  v_dot2_f32_bf16 v29, v62, v18, v29
  s_nop 2
  v_dot2_f32_bf16 v29, v63, v19, v29
  global_load_dwordx4 v[60:63], v1, s[44:45] offset:1024 nt
  v_add_f32_dpp v32, v33, v33 row_ror:8 row_mask:0xf bank_mask:0xc
  v_add_f32_dpp v34, v35, v35 row_ror:8 row_mask:0xf bank_mask:0xc
  s_waitcnt vmcnt(15)
  v_dot2_f32_bf16 v30, v64, v16, 0
  s_nop 2
  v_dot2_f32_bf16 v30, v65, v17, v30
  s_nop 2
  v_dot2_f32_bf16 v30, v66, v18, v30
  s_nop 2
  v_dot2_f32_bf16 v30, v67, v19, v30
  global_load_dwordx4 v[64:67], v1, s[44:45] offset:2048 nt
  v_add_f32_dpp v32, v32, v32 row_ror:12 row_mask:0xf bank_mask:0xf
  s_nop 1
  v_add_f32_dpp v32, v34, v34 row_ror:4 row_mask:0xf bank_mask:0xa
  s_waitcnt vmcnt(15)
  v_dot2_f32_bf16 v31, v68, v16, 0
  s_nop 2
  v_dot2_f32_bf16 v31, v69, v17, v31
  s_nop 2
  v_dot2_f32_bf16 v31, v70, v18, v31
  s_nop 2
  v_dot2_f32_bf16 v31, v71, v19, v31
  global_load_dwordx4 v[68:71], v1, s[44:45] offset:3072 nt
  s_add_u32 s44, s44, 4096
  s_addc_u32 s45, s45, 0
  v_add_f32_dpp v32, v32, v32 quad_perm:[2,3,0,1] row_mask:0xf bank_mask:0xf
  s_nop 1
  v_add_f32_dpp v45, v32, v32 quad_perm:[1,0,3,2] row_mask:0xf bank_mask:0xf bound_ctrl:0
  s_waitcnt vmcnt(15)
  v_dot2_f32_bf16 v32, v72, v16, 0
  s_nop 2
  v_dot2_f32_bf16 v32, v73, v17, v32
  s_nop 2
  v_dot2_f32_bf16 v32, v74, v18, v32
  s_nop 2
  v_dot2_f32_bf16 v32, v75, v19, v32
  global_load_dwordx4 v[72:75], v1, s[44:45] offset:0 nt
  v_add_f32_dpp v28, v28, v28 row_ror:8 row_mask:0xf bank_mask:0xf
  v_add_f32_dpp v30, v30, v30 row_ror:8 row_mask:0xf bank_mask:0xf
  s_waitcnt vmcnt(15)
  v_dot2_f32_bf16 v33, v76, v16, 0
  s_nop 2
  v_dot2_f32_bf16 v33, v77, v17, v33
  s_nop 2
  v_dot2_f32_bf16 v33, v78, v18, v33
  s_nop 2
  v_dot2_f32_bf16 v33, v79, v19, v33
  global_load_dwordx4 v[76:79], v1, s[44:45] offset:1024 nt
  v_add_f32_dpp v28, v29, v29 row_ror:8 row_mask:0xf bank_mask:0xc
  v_add_f32_dpp v30, v31, v31 row_ror:8 row_mask:0xf bank_mask:0xc
  s_waitcnt vmcnt(15)
  v_dot2_f32_bf16 v34, v80, v16, 0
  s_nop 2
  v_dot2_f32_bf16 v34, v81, v17, v34
  s_nop 2
  v_dot2_f32_bf16 v34, v82, v18, v34
  s_nop 2
  v_dot2_f32_bf16 v34, v83, v19, v34
  global_load_dwordx4 v[80:83], v1, s[44:45] offset:2048 nt
  v_add_f32_dpp v28, v28, v28 row_ror:12 row_mask:0xf bank_mask:0xf
  s_nop 1
  v_add_f32_dpp v28, v30, v30 row_ror:4 row_mask:0xf bank_mask:0xa
  s_waitcnt vmcnt(15)
  v_dot2_f32_bf16 v35, v84, v16, 0
  s_nop 2
  v_dot2_f32_bf16 v35, v85, v17, v35
  s_nop 2
  v_dot2_f32_bf16 v35, v86, v18, v35
  s_nop 2
  v_dot2_f32_bf16 v35, v87, v19, v35
  global_load_dwordx4 v[84:87], v1, s[44:45] offset:3072 nt
  s_add_u32 s44, s44, 4096
  s_addc_u32 s45, s45, 0
  v_add_f32_dpp v28, v28, v28 quad_perm:[2,3,0,1] row_mask:0xf bank_mask:0xf
  s_nop 1
  v_add_f32_dpp v46, v28, v28 quad_perm:[1,0,3,2] row_mask:0xf bank_mask:0xf bound_ctrl:0
  s_waitcnt vmcnt(15)
  v_dot2_f32_bf16 v28, v88, v16, 0
  s_nop 2
  v_dot2_f32_bf16 v28, v89, v17, v28
  s_nop 2
  v_dot2_f32_bf16 v28, v90, v18, v28
  s_nop 2
  v_dot2_f32_bf16 v28, v91, v19, v28
  global_load_dwordx4 v[88:91], v1, s[46:47] offset:0 nt
  v_add_f32_dpp v32, v32, v32 row_ror:8 row_mask:0xf bank_mask:0xf
  v_add_f32_dpp v34, v34, v34 row_ror:8 row_mask:0xf bank_mask:0xf
  s_waitcnt vmcnt(15)
  v_dot2_f32_bf16 v29, v92, v16, 0
  s_nop 2
  v_dot2_f32_bf16 v29, v93, v17, v29
  s_nop 2
  v_dot2_f32_bf16 v29, v94, v18, v29
  s_nop 2
  v_dot2_f32_bf16 v29, v95, v19, v29
  global_load_dwordx4 v[92:95], v1, s[46:47] offset:1024 nt
  v_add_f32_dpp v32, v33, v33 row_ror:8 row_mask:0xf bank_mask:0xc
  v_add_f32_dpp v34, v35, v35 row_ror:8 row_mask:0xf bank_mask:0xc
  s_waitcnt vmcnt(15)
  v_dot2_f32_bf16 v30, v96, v16, 0
  s_nop 2
  v_dot2_f32_bf16 v30, v97, v17, v30
  s_nop 2
  v_dot2_f32_bf16 v30, v98, v18, v30
  s_nop 2
  v_dot2_f32_bf16 v30, v99, v19, v30
  global_load_dwordx4 v[96:99], v1, s[46:47] offset:2048 nt
  v_add_f32_dpp v32, v32, v32 row_ror:12 row_mask:0xf bank_mask:0xf
  s_nop 1
  v_add_f32_dpp v32, v34, v34 row_ror:4 row_mask:0xf bank_mask:0xa
  s_waitcnt vmcnt(15)
  v_dot2_f32_bf16 v31, v100, v16, 0
  s_nop 2
  v_dot2_f32_bf16 v31, v101, v17, v31
  s_nop 2
  v_dot2_f32_bf16 v31, v102, v18, v31
  s_nop 2
  v_dot2_f32_bf16 v31, v103, v19, v31
  global_load_dwordx4 v[100:103], v1, s[46:47] offset:3072 nt
  s_add_u32 s46, s46, 4096
  s_addc_u32 s47, s47, 0
  v_add_f32_dpp v32, v32, v32 quad_perm:[2,3,0,1] row_mask:0xf bank_mask:0xf
  s_nop 1
  v_add_f32_dpp v47, v32, v32 quad_perm:[1,0,3,2] row_mask:0xf bank_mask:0xf bound_ctrl:0
  s_waitcnt vmcnt(15)
  v_dot2_f32_bf16 v32, v104, v16, 0
  s_nop 2
  v_dot2_f32_bf16 v32, v105, v17, v32
  s_nop 2
  v_dot2_f32_bf16 v32, v106, v18, v32
  s_nop 2
  v_dot2_f32_bf16 v32, v107, v19, v32
  global_load_dwordx4 v[104:107], v1, s[46:47] offset:0 nt
  v_add_f32_dpp v28, v28, v28 row_ror:8 row_mask:0xf bank_mask:0xf
  v_add_f32_dpp v30, v30, v30 row_ror:8 row_mask:0xf bank_mask:0xf
  s_waitcnt vmcnt(15)
  v_dot2_f32_bf16 v33, v108, v16, 0
  s_nop 2
  v_dot2_f32_bf16 v33, v109, v17, v33
  s_nop 2
  v_dot2_f32_bf16 v33, v110, v18, v33
  s_nop 2
  v_dot2_f32_bf16 v33, v111, v19, v33
  global_load_dwordx4 v[108:111], v1, s[46:47] offset:1024 nt
  v_add_f32_dpp v28, v29, v29 row_ror:8 row_mask:0xf bank_mask:0xc
  v_add_f32_dpp v30, v31, v31 row_ror:8 row_mask:0xf bank_mask:0xc
  s_waitcnt vmcnt(15)
  v_dot2_f32_bf16 v34, v112, v16, 0
  s_nop 2
  v_dot2_f32_bf16 v34, v113, v17, v34
  s_nop 2
  v_dot2_f32_bf16 v34, v114, v18, v34
  s_nop 2
  v_dot2_f32_bf16 v34, v115, v19, v34
  global_load_dwordx4 v[112:115], v1, s[46:47] offset:2048 nt
  v_add_f32_dpp v28, v28, v28 row_ror:12 row_mask:0xf bank_mask:0xf
  s_nop 1
  v_add_f32_dpp v28, v30, v30 row_ror:4 row_mask:0xf bank_mask:0xa
  s_waitcnt vmcnt(15)
  v_dot2_f32_bf16 v35, v116, v16, 0
  s_nop 2
  v_dot2_f32_bf16 v35, v117, v17, v35
  s_nop 2
  v_dot2_f32_bf16 v35, v118, v18, v35
  s_nop 2
  v_dot2_f32_bf16 v35, v119, v19, v35
  global_load_dwordx4 v[116:119], v1, s[46:47] offset:3072 nt
  s_add_u32 s46, s46, 4096
  s_addc_u32 s47, s47, 0
  v_add_f32_dpp v28, v28, v28 quad_perm:[2,3,0,1] row_mask:0xf bank_mask:0xf
  s_nop 1
  v_add_f32_dpp v48, v28, v28 quad_perm:[1,0,3,2] row_mask:0xf bank_mask:0xf bound_ctrl:0
  s_waitcnt vmcnt(15)
  v_dot2_f32_bf16 v28, v56, v16, 0
  s_nop 2
  v_dot2_f32_bf16 v28, v57, v17, v28
  s_nop 2
  v_dot2_f32_bf16 v28, v58, v18, v28
  s_nop 2
  v_dot2_f32_bf16 v28, v59, v19, v28
  global_load_dwordx4 v[56:59], v1, s[46:47] offset:0 nt
  v_add_f32_dpp v32, v32, v32 row_ror:8 row_mask:0xf bank_mask:0xf
  v_add_f32_dpp v34, v34, v34 row_ror:8 row_mask:0xf bank_mask:0xf
  s_waitcnt vmcnt(15)
  v_dot2_f32_bf16 v29, v60, v16, 0
  s_nop 2
  v_dot2_f32_bf16 v29, v61, v17, v29
  s_nop 2
  v_dot2_f32_bf16 v29, v62, v18, v29
  s_nop 2
  v_dot2_f32_bf16 v29, v63, v19, v29
  global_load_dwordx4 v[60:63], v1, s[46:47] offset:1024 nt
  v_add_f32_dpp v32, v33, v33 row_ror:8 row_mask:0xf bank_mask:0xc
  v_add_f32_dpp v34, v35, v35 row_ror:8 row_mask:0xf bank_mask:0xc
  s_waitcnt vmcnt(15)
  v_dot2_f32_bf16 v30, v64, v16, 0
  s_nop 2
  v_dot2_f32_bf16 v30, v65, v17, v30
  s_nop 2
  v_dot2_f32_bf16 v30, v66, v18, v30
  s_nop 2
  v_dot2_f32_bf16 v30, v67, v19, v30
  global_load_dwordx4 v[64:67], v1, s[46:47] offset:2048 nt
  v_add_f32_dpp v32, v32, v32 row_ror:12 row_mask:0xf bank_mask:0xf
  s_nop 1
  v_add_f32_dpp v32, v34, v34 row_ror:4 row_mask:0xf bank_mask:0xa
  s_waitcnt vmcnt(15)
  v_dot2_f32_bf16 v31, v68, v16, 0
  s_nop 2
  v_dot2_f32_bf16 v31, v69, v17, v31
  s_nop 2
  v_dot2_f32_bf16 v31, v70, v18, v31
  s_nop 2
  v_dot2_f32_bf16 v31, v71, v19, v31
  global_load_dwordx4 v[68:71], v1, s[46:47] offset:3072 nt
  s_add_u32 s46, s46, 4096
  s_addc_u32 s47, s47, 0
  v_add_f32_dpp v32, v32, v32 quad_perm:[2,3,0,1] row_mask:0xf bank_mask:0xf
  s_nop 1
  v_add_f32_dpp v49, v32, v32 quad_perm:[1,0,3,2] row_mask:0xf bank_mask:0xf bound_ctrl:0
  s_waitcnt vmcnt(15)
  v_dot2_f32_bf16 v32, v72, v16, 0
  s_nop 2
  v_dot2_f32_bf16 v32, v73, v17, v32
  s_nop 2
  v_dot2_f32_bf16 v32, v74, v18, v32
  s_nop 2
  v_dot2_f32_bf16 v32, v75, v19, v32
  global_load_dwordx4 v[72:75], v1, s[46:47] offset:0 nt
  v_add_f32_dpp v28, v28, v28 row_ror:8 row_mask:0xf bank_mask:0xf
  v_add_f32_dpp v30, v30, v30 row_ror:8 row_mask:0xf bank_mask:0xf
  s_waitcnt vmcnt(15)
  v_dot2_f32_bf16 v33, v76, v16, 0
  s_nop 2
  v_dot2_f32_bf16 v33, v77, v17, v33
  s_nop 2
  v_dot2_f32_bf16 v33, v78, v18, v33
  s_nop 2
  v_dot2_f32_bf16 v33, v79, v19, v33
  global_load_dwordx4 v[76:79], v1, s[46:47] offset:1024 nt
  v_add_f32_dpp v28, v29, v29 row_ror:8 row_mask:0xf bank_mask:0xc
  v_add_f32_dpp v30, v31, v31 row_ror:8 row_mask:0xf bank_mask:0xc
  s_waitcnt vmcnt(15)
  v_dot2_f32_bf16 v34, v80, v16, 0
  s_nop 2
  v_dot2_f32_bf16 v34, v81, v17, v34
  s_nop 2
  v_dot2_f32_bf16 v34, v82, v18, v34
  s_nop 2
  v_dot2_f32_bf16 v34, v83, v19, v34
  global_load_dwordx4 v[80:83], v1, s[46:47] offset:2048 nt
  v_add_f32_dpp v28, v28, v28 row_ror:12 row_mask:0xf bank_mask:0xf
  s_nop 1
  v_add_f32_dpp v28, v30, v30 row_ror:4 row_mask:0xf bank_mask:0xa
  s_waitcnt vmcnt(15)
  v_dot2_f32_bf16 v35, v84, v16, 0
  s_nop 2
  v_dot2_f32_bf16 v35, v85, v17, v35
  s_nop 2
  v_dot2_f32_bf16 v35, v86, v18, v35
  s_nop 2
  v_dot2_f32_bf16 v35, v87, v19, v35
  global_load_dwordx4 v[84:87], v1, s[46:47] offset:3072 nt
  s_add_u32 s46, s46, 4096
  s_addc_u32 s47, s47, 0
  v_add_f32_dpp v28, v28, v28 quad_perm:[2,3,0,1] row_mask:0xf bank_mask:0xf
  s_nop 1
  v_add_f32_dpp v50, v28, v28 quad_perm:[1,0,3,2] row_mask:0xf bank_mask:0xf bound_ctrl:0
  v_add_f32_dpp v32, v32, v32 row_ror:8 row_mask:0xf bank_mask:0xf
  v_add_f32_dpp v34, v34, v34 row_ror:8 row_mask:0xf bank_mask:0xf
  s_nop 0
  v_add_f32_dpp v32, v33, v33 row_ror:8 row_mask:0xf bank_mask:0xc
  v_add_f32_dpp v34, v35, v35 row_ror:8 row_mask:0xf bank_mask:0xc
  s_nop 0
  v_add_f32_dpp v32, v32, v32 row_ror:12 row_mask:0xf bank_mask:0xf
  s_nop 1
  v_add_f32_dpp v32, v34, v34 row_ror:4 row_mask:0xf bank_mask:0xa
  s_nop 1
  v_add_f32_dpp v32, v32, v32 quad_perm:[2,3,0,1] row_mask:0xf bank_mask:0xf
  s_nop 1
  v_add_f32_dpp v51, v32, v32 quad_perm:[1,0,3,2] row_mask:0xf bank_mask:0xf bound_ctrl:0
  v_cvt_pk_bf16_f32 v36, v36, v36
  v_lshlrev_b32 v36, 16, v36
  v_mul_f32 v36, s51, v36
  v_cvt_pk_bf16_f32 v36, v36, v36
  v_lshlrev_b32 v36, 16, v36
  v_cvt_pk_bf16_f32 v37, v37, v37
  v_lshlrev_b32 v37, 16, v37
  v_mul_f32 v37, s51, v37
  v_cvt_pk_bf16_f32 v37, v37, v37
  v_lshlrev_b32 v37, 16, v37
  v_cvt_pk_bf16_f32 v38, v38, v38
  v_lshlrev_b32 v38, 16, v38
  v_mul_f32 v38, s51, v38
  v_cvt_pk_bf16_f32 v38, v38, v38
  v_lshlrev_b32 v38, 16, v38
  v_cvt_pk_bf16_f32 v39, v39, v39
  v_lshlrev_b32 v39, 16, v39
  v_mul_f32 v39, s51, v39
  v_cvt_pk_bf16_f32 v39, v39, v39
  v_lshlrev_b32 v39, 16, v39
  v_cvt_pk_bf16_f32 v40, v40, v40
  v_lshlrev_b32 v40, 16, v40
  v_mul_f32 v40, s51, v40
  v_cvt_pk_bf16_f32 v40, v40, v40
  v_lshlrev_b32 v40, 16, v40
  v_cvt_pk_bf16_f32 v41, v41, v41
  v_lshlrev_b32 v41, 16, v41
  v_mul_f32 v41, s51, v41
  v_cvt_pk_bf16_f32 v41, v41, v41
  v_lshlrev_b32 v41, 16, v41
  v_cvt_pk_bf16_f32 v42, v42, v42
  v_lshlrev_b32 v42, 16, v42
  v_mul_f32 v42, s51, v42
  v_cvt_pk_bf16_f32 v42, v42, v42
  v_lshlrev_b32 v42, 16, v42
  v_cvt_pk_bf16_f32 v43, v43, v43
  v_lshlrev_b32 v43, 16, v43
  v_mul_f32 v43, s51, v43
  v_cvt_pk_bf16_f32 v43, v43, v43
  v_lshlrev_b32 v43, 16, v43
  v_cvt_pk_bf16_f32 v44, v44, v44
  v_lshlrev_b32 v44, 16, v44
  v_mul_f32 v44, s51, v44
  v_cvt_pk_bf16_f32 v44, v44, v44
  v_lshlrev_b32 v44, 16, v44
  v_cvt_pk_bf16_f32 v45, v45, v45
  v_lshlrev_b32 v45, 16, v45
  v_mul_f32 v45, s51, v45
  v_cvt_pk_bf16_f32 v45, v45, v45
  v_lshlrev_b32 v45, 16, v45
  v_cvt_pk_bf16_f32 v46, v46, v46
  v_lshlrev_b32 v46, 16, v46
  v_mul_f32 v46, s51, v46
  v_cvt_pk_bf16_f32 v46, v46, v46
  v_lshlrev_b32 v46, 16, v46
  v_cvt_pk_bf16_f32 v47, v47, v47
  v_lshlrev_b32 v47, 16, v47
  v_mul_f32 v47, s51, v47
  v_cvt_pk_bf16_f32 v47, v47, v47
  v_lshlrev_b32 v47, 16, v47
  v_cvt_pk_bf16_f32 v48, v48, v48
  v_lshlrev_b32 v48, 16, v48
  v_mul_f32 v48, s51, v48
  v_cvt_pk_bf16_f32 v48, v48, v48
  v_lshlrev_b32 v48, 16, v48
  v_cvt_pk_bf16_f32 v49, v49, v49
  v_lshlrev_b32 v49, 16, v49
  v_mul_f32 v49, s51, v49
  v_cvt_pk_bf16_f32 v49, v49, v49
  v_lshlrev_b32 v49, 16, v49
  v_cvt_pk_bf16_f32 v50, v50, v50
  v_lshlrev_b32 v50, 16, v50
  v_mul_f32 v50, s51, v50
  v_cvt_pk_bf16_f32 v50, v50, v50
  v_lshlrev_b32 v50, 16, v50
  v_cvt_pk_bf16_f32 v51, v51, v51
  v_lshlrev_b32 v51, 16, v51
  v_mul_f32 v51, s51, v51
  v_cvt_pk_bf16_f32 v51, v51, v51
  v_lshlrev_b32 v51, 16, v51
  v_max3_f32 v7, v36, v37, v38
  v_max3_f32 v7, v7, v39, v40
  v_max3_f32 v7, v7, v41, v42
  v_max3_f32 v7, v7, v43, v44
  v_max3_f32 v7, v7, v45, v46
  v_max3_f32 v7, v7, v47, v48
  v_max3_f32 v7, v7, v49, v50
  v_max_f32 v7, v7, v51
  s_nop 1
  v_max_f32_dpp v7, v7, v7 row_ror:8 row_mask:0xf bank_mask:0xf
  s_nop 1
  v_max_f32_dpp v7, v7, v7 row_ror:4 row_mask:0xf bank_mask:0xf
  v_mov_b32 v14, v7
  s_nop 1
  v_permlane16_swap_b32 v7, v14
  v_max_f32 v7, v7, v14
  v_mov_b32 v14, v7
  s_nop 1
  v_permlane32_swap_b32 v7, v14
  v_max_f32 v7, v7, v14
  v_mov_b32 v12, 0
  v_sub_f32 v14, v36, v7
  v_mul_f32 v14, s50, v14
  v_exp_f32 v14, v14
  s_nop 0
  v_add_f32 v12, v12, v14
  v_sub_f32 v14, v37, v7
  v_mul_f32 v14, s50, v14
  v_exp_f32 v14, v14
  s_nop 0
  v_add_f32 v12, v12, v14
  v_sub_f32 v14, v38, v7
  v_mul_f32 v14, s50, v14
  v_exp_f32 v14, v14
  s_nop 0
  v_add_f32 v12, v12, v14
  v_sub_f32 v14, v39, v7
  v_mul_f32 v14, s50, v14
  v_exp_f32 v14, v14
  s_nop 0
  v_add_f32 v12, v12, v14
  v_sub_f32 v14, v40, v7
  v_mul_f32 v14, s50, v14
  v_exp_f32 v14, v14
  s_nop 0
  v_add_f32 v12, v12, v14
  v_sub_f32 v14, v41, v7
  v_mul_f32 v14, s50, v14
  v_exp_f32 v14, v14
  s_nop 0
  v_add_f32 v12, v12, v14
  v_sub_f32 v14, v42, v7
  v_mul_f32 v14, s50, v14
  v_exp_f32 v14, v14
  s_nop 0
  v_add_f32 v12, v12, v14
  v_sub_f32 v14, v43, v7
  v_mul_f32 v14, s50, v14
  v_exp_f32 v14, v14
  s_nop 0
  v_add_f32 v12, v12, v14
  v_sub_f32 v14, v44, v7
  v_mul_f32 v14, s50, v14
  v_exp_f32 v14, v14
  s_nop 0
  v_add_f32 v12, v12, v14
  v_sub_f32 v14, v45, v7
  v_mul_f32 v14, s50, v14
  v_exp_f32 v14, v14
  s_nop 0
  v_add_f32 v12, v12, v14
  v_sub_f32 v14, v46, v7
  v_mul_f32 v14, s50, v14
  v_exp_f32 v14, v14
  s_nop 0
  v_add_f32 v12, v12, v14
  v_sub_f32 v14, v47, v7
  v_mul_f32 v14, s50, v14
  v_exp_f32 v14, v14
  s_nop 0
  v_add_f32 v12, v12, v14
  v_sub_f32 v14, v48, v7
  v_mul_f32 v14, s50, v14
  v_exp_f32 v14, v14
  s_nop 0
  v_add_f32 v12, v12, v14
  v_sub_f32 v14, v49, v7
  v_mul_f32 v14, s50, v14
  v_exp_f32 v14, v14
  s_nop 0
  v_add_f32 v12, v12, v14
  v_sub_f32 v14, v50, v7
  v_mul_f32 v14, s50, v14
  v_exp_f32 v14, v14
  s_nop 0
  v_add_f32 v12, v12, v14
  v_sub_f32 v14, v51, v7
  v_mul_f32 v14, s50, v14
  v_exp_f32 v14, v14
  s_nop 0
  v_add_f32 v12, v12, v14
  s_nop 1
  v_add_f32_dpp v12, v12, v12 row_ror:8 row_mask:0xf bank_mask:0xf
  s_nop 1
  v_add_f32_dpp v12, v12, v12 row_ror:4 row_mask:0xf bank_mask:0xf
  v_mov_b32 v14, v12
  s_nop 1
  v_permlane16_swap_b32 v12, v14
  v_add_f32 v12, v12, v14
  v_mov_b32 v14, v12
  s_nop 1
  v_permlane32_swap_b32 v12, v14
  v_add_f32 v12, v12, v14
  v_mov_b32 v8, v7
  v_mov_b32 v9, v12
  s_lshl_b32 s7, s6, 3
  v_mov_b32 v14, s7
  s_mov_b64 exec, 1
  ds_write_b64 v14, v[8:9] offset:37120
  s_mov_b64 exec, -1
  s_waitcnt lgkmcnt(0)
  s_barrier
  v_lshlrev_b32 v14, 3, v2
  ds_read_b64 v[8:9], v14 offset:37120
  s_waitcnt lgkmcnt(0)
  v_mov_b32 v7, v8
  s_nop 1
  v_max_f32_dpp v7, v7, v7 row_ror:8 row_mask:0xf bank_mask:0xf
  s_nop 1
  v_max_f32_dpp v7, v7, v7 row_ror:4 row_mask:0xf bank_mask:0xf
  s_nop 1
  v_max_f32_dpp v7, v7, v7 row_ror:2 row_mask:0xf bank_mask:0xf
  s_nop 1
  v_max_f32_dpp v7, v7, v7 row_ror:1 row_mask:0xf bank_mask:0xf
  v_sub_f32 v14, v8, v7
  v_mul_f32 v14, s50, v14
  v_exp_f32 v14, v14
  s_nop 0
  v_mul_f32 v12, v9, v14
  s_nop 1
  v_add_f32_dpp v12, v12, v12 row_ror:8 row_mask:0xf bank_mask:0xf
  s_nop 1
  v_add_f32_dpp v12, v12, v12 row_ror:4 row_mask:0xf bank_mask:0xf
  s_nop 1
  v_add_f32_dpp v12, v12, v12 row_ror:2 row_mask:0xf bank_mask:0xf
  s_nop 1
  v_add_f32_dpp v12, v12, v12 row_ror:1 row_mask:0xf bank_mask:0xf
  v_rcp_f32 v12, v12
  v_sub_f32 v14, v36, v7
  v_mul_f32 v14, s50, v14
  v_exp_f32 v14, v14
  s_nop 0
  v_mul_f32 v14, v14, v12
  v_cvt_pk_bf16_f32 v36, v14, 0
  v_sub_f32 v14, v37, v7
  v_mul_f32 v14, s50, v14
  v_exp_f32 v14, v14
  s_nop 0
  v_mul_f32 v14, v14, v12
  v_cvt_pk_bf16_f32 v37, v14, 0
  v_sub_f32 v14, v38, v7
  v_mul_f32 v14, s50, v14
  v_exp_f32 v14, v14
  s_nop 0
  v_mul_f32 v14, v14, v12
  v_cvt_pk_bf16_f32 v38, v14, 0
  v_sub_f32 v14, v39, v7
  v_mul_f32 v14, s50, v14
  v_exp_f32 v14, v14
  s_nop 0
  v_mul_f32 v14, v14, v12
  v_cvt_pk_bf16_f32 v39, v14, 0
  v_sub_f32 v14, v40, v7
  v_mul_f32 v14, s50, v14
  v_exp_f32 v14, v14
  s_nop 0
  v_mul_f32 v14, v14, v12
  v_cvt_pk_bf16_f32 v40, v14, 0
  v_sub_f32 v14, v41, v7
  v_mul_f32 v14, s50, v14
  v_exp_f32 v14, v14
  s_nop 0
  v_mul_f32 v14, v14, v12
  v_cvt_pk_bf16_f32 v41, v14, 0
  v_sub_f32 v14, v42, v7
  v_mul_f32 v14, s50, v14
  v_exp_f32 v14, v14
  s_nop 0
  v_mul_f32 v14, v14, v12
  v_cvt_pk_bf16_f32 v42, v14, 0
  v_sub_f32 v14, v43, v7
  v_mul_f32 v14, s50, v14
  v_exp_f32 v14, v14
  s_nop 0
  v_mul_f32 v14, v14, v12
  v_cvt_pk_bf16_f32 v43, v14, 0
  v_sub_f32 v14, v44, v7
  v_mul_f32 v14, s50, v14
  v_exp_f32 v14, v14
  s_nop 0
  v_mul_f32 v14, v14, v12
  v_cvt_pk_bf16_f32 v44, v14, 0
  v_sub_f32 v14, v45, v7
  v_mul_f32 v14, s50, v14
  v_exp_f32 v14, v14
  s_nop 0
  v_mul_f32 v14, v14, v12
  v_cvt_pk_bf16_f32 v45, v14, 0
  v_sub_f32 v14, v46, v7
  v_mul_f32 v14, s50, v14
  v_exp_f32 v14, v14
  s_nop 0
  v_mul_f32 v14, v14, v12
  v_cvt_pk_bf16_f32 v46, v14, 0
  v_sub_f32 v14, v47, v7
  v_mul_f32 v14, s50, v14
  v_exp_f32 v14, v14
  s_nop 0
  v_mul_f32 v14, v14, v12
  v_cvt_pk_bf16_f32 v47, v14, 0
  v_sub_f32 v14, v48, v7
  v_mul_f32 v14, s50, v14
  v_exp_f32 v14, v14
  s_nop 0
  v_mul_f32 v14, v14, v12
  v_cvt_pk_bf16_f32 v48, v14, 0
  v_sub_f32 v14, v49, v7
  v_mul_f32 v14, s50, v14
  v_exp_f32 v14, v14
  s_nop 0
  v_mul_f32 v14, v14, v12
  v_cvt_pk_bf16_f32 v49, v14, 0
  v_sub_f32 v14, v50, v7
  v_mul_f32 v14, s50, v14
  v_exp_f32 v14, v14
  s_nop 0
  v_mul_f32 v14, v14, v12
  v_cvt_pk_bf16_f32 v50, v14, 0
  v_sub_f32 v14, v51, v7
  v_mul_f32 v14, s50, v14
  v_exp_f32 v14, v14
  s_nop 0
  v_mul_f32 v14, v14, v12
  v_cvt_pk_bf16_f32 v51, v14, 0
  v_mov_b32 v20, 0
  v_mov_b32 v21, 0
  v_mov_b32 v22, 0
  v_mov_b32 v23, 0
  v_mov_b32 v24, 0
  v_mov_b32 v25, 0
  v_mov_b32 v26, 0
  v_mov_b32 v27, 0
  v_lshlrev_b32 v52, 16, v36
  s_waitcnt vmcnt(15)
  v_dot2c_f32_bf16_dpp v20, v36, v88 row_newbcast:0 row_mask:0xf bank_mask:0xf
  v_dot2c_f32_bf16_dpp v21, v52, v88 row_newbcast:0 row_mask:0xf bank_mask:0xf
  v_dot2c_f32_bf16_dpp v22, v36, v89 row_newbcast:0 row_mask:0xf bank_mask:0xf
  v_dot2c_f32_bf16_dpp v23, v52, v89 row_newbcast:0 row_mask:0xf bank_mask:0xf
  v_dot2c_f32_bf16_dpp v24, v36, v90 row_newbcast:0 row_mask:0xf bank_mask:0xf
  v_dot2c_f32_bf16_dpp v25, v52, v90 row_newbcast:0 row_mask:0xf bank_mask:0xf
  v_dot2c_f32_bf16_dpp v26, v36, v91 row_newbcast:0 row_mask:0xf bank_mask:0xf
  v_dot2c_f32_bf16_dpp v27, v52, v91 row_newbcast:0 row_mask:0xf bank_mask:0xf
  global_load_dwordx4 v[88:91], v1, s[46:47] offset:0 nt
  s_waitcnt vmcnt(15)
  v_dot2c_f32_bf16_dpp v20, v36, v92 row_newbcast:8 row_mask:0xf bank_mask:0xf
  v_dot2c_f32_bf16_dpp v21, v52, v92 row_newbcast:8 row_mask:0xf bank_mask:0xf
  v_dot2c_f32_bf16_dpp v22, v36, v93 row_newbcast:8 row_mask:0xf bank_mask:0xf
  v_dot2c_f32_bf16_dpp v23, v52, v93 row_newbcast:8 row_mask:0xf bank_mask:0xf
  v_dot2c_f32_bf16_dpp v24, v36, v94 row_newbcast:8 row_mask:0xf bank_mask:0xf
  v_dot2c_f32_bf16_dpp v25, v52, v94 row_newbcast:8 row_mask:0xf bank_mask:0xf
  v_dot2c_f32_bf16_dpp v26, v36, v95 row_newbcast:8 row_mask:0xf bank_mask:0xf
  v_dot2c_f32_bf16_dpp v27, v52, v95 row_newbcast:8 row_mask:0xf bank_mask:0xf
  global_load_dwordx4 v[92:95], v1, s[46:47] offset:1024 nt
  s_waitcnt vmcnt(15)
  v_dot2c_f32_bf16_dpp v20, v36, v96 row_newbcast:4 row_mask:0xf bank_mask:0xf
  v_dot2c_f32_bf16_dpp v21, v52, v96 row_newbcast:4 row_mask:0xf bank_mask:0xf
  v_dot2c_f32_bf16_dpp v22, v36, v97 row_newbcast:4 row_mask:0xf bank_mask:0xf
  v_dot2c_f32_bf16_dpp v23, v52, v97 row_newbcast:4 row_mask:0xf bank_mask:0xf
  v_dot2c_f32_bf16_dpp v24, v36, v98 row_newbcast:4 row_mask:0xf bank_mask:0xf
  v_dot2c_f32_bf16_dpp v25, v52, v98 row_newbcast:4 row_mask:0xf bank_mask:0xf
  v_dot2c_f32_bf16_dpp v26, v36, v99 row_newbcast:4 row_mask:0xf bank_mask:0xf
  v_dot2c_f32_bf16_dpp v27, v52, v99 row_newbcast:4 row_mask:0xf bank_mask:0xf
  global_load_dwordx4 v[96:99], v1, s[46:47] offset:2048 nt
  s_waitcnt vmcnt(15)
  v_dot2c_f32_bf16_dpp v20, v36, v100 row_newbcast:12 row_mask:0xf bank_mask:0xf
  v_dot2c_f32_bf16_dpp v21, v52, v100 row_newbcast:12 row_mask:0xf bank_mask:0xf
  v_dot2c_f32_bf16_dpp v22, v36, v101 row_newbcast:12 row_mask:0xf bank_mask:0xf
  v_dot2c_f32_bf16_dpp v23, v52, v101 row_newbcast:12 row_mask:0xf bank_mask:0xf
  v_dot2c_f32_bf16_dpp v24, v36, v102 row_newbcast:12 row_mask:0xf bank_mask:0xf
  v_dot2c_f32_bf16_dpp v25, v52, v102 row_newbcast:12 row_mask:0xf bank_mask:0xf
  v_dot2c_f32_bf16_dpp v26, v36, v103 row_newbcast:12 row_mask:0xf bank_mask:0xf
  v_dot2c_f32_bf16_dpp v27, v52, v103 row_newbcast:12 row_mask:0xf bank_mask:0xf
  global_load_dwordx4 v[100:103], v1, s[46:47] offset:3072 nt
  s_add_u32 s46, s46, 4096
  s_addc_u32 s47, s47, 0
  v_lshlrev_b32 v53, 16, v37
  s_waitcnt vmcnt(15)
  v_dot2c_f32_bf16_dpp v20, v37, v104 row_newbcast:0 row_mask:0xf bank_mask:0xf
  v_dot2c_f32_bf16_dpp v21, v53, v104 row_newbcast:0 row_mask:0xf bank_mask:0xf
  v_dot2c_f32_bf16_dpp v22, v37, v105 row_newbcast:0 row_mask:0xf bank_mask:0xf
  v_dot2c_f32_bf16_dpp v23, v53, v105 row_newbcast:0 row_mask:0xf bank_mask:0xf
  v_dot2c_f32_bf16_dpp v24, v37, v106 row_newbcast:0 row_mask:0xf bank_mask:0xf
  v_dot2c_f32_bf16_dpp v25, v53, v106 row_newbcast:0 row_mask:0xf bank_mask:0xf
  v_dot2c_f32_bf16_dpp v26, v37, v107 row_newbcast:0 row_mask:0xf bank_mask:0xf
  v_dot2c_f32_bf16_dpp v27, v53, v107 row_newbcast:0 row_mask:0xf bank_mask:0xf
  global_load_dwordx4 v[104:107], v1, s[46:47] offset:0 nt
  s_waitcnt vmcnt(15)
  v_dot2c_f32_bf16_dpp v20, v37, v108 row_newbcast:8 row_mask:0xf bank_mask:0xf
  v_dot2c_f32_bf16_dpp v21, v53, v108 row_newbcast:8 row_mask:0xf bank_mask:0xf
  v_dot2c_f32_bf16_dpp v22, v37, v109 row_newbcast:8 row_mask:0xf bank_mask:0xf
  v_dot2c_f32_bf16_dpp v23, v53, v109 row_newbcast:8 row_mask:0xf bank_mask:0xf
  v_dot2c_f32_bf16_dpp v24, v37, v110 row_newbcast:8 row_mask:0xf bank_mask:0xf
  v_dot2c_f32_bf16_dpp v25, v53, v110 row_newbcast:8 row_mask:0xf bank_mask:0xf
  v_dot2c_f32_bf16_dpp v26, v37, v111 row_newbcast:8 row_mask:0xf bank_mask:0xf
  v_dot2c_f32_bf16_dpp v27, v53, v111 row_newbcast:8 row_mask:0xf bank_mask:0xf
  global_load_dwordx4 v[108:111], v1, s[46:47] offset:1024 nt
  s_waitcnt vmcnt(15)
  v_dot2c_f32_bf16_dpp v20, v37, v112 row_newbcast:4 row_mask:0xf bank_mask:0xf
  v_dot2c_f32_bf16_dpp v21, v53, v112 row_newbcast:4 row_mask:0xf bank_mask:0xf
  v_dot2c_f32_bf16_dpp v22, v37, v113 row_newbcast:4 row_mask:0xf bank_mask:0xf
  v_dot2c_f32_bf16_dpp v23, v53, v113 row_newbcast:4 row_mask:0xf bank_mask:0xf
  v_dot2c_f32_bf16_dpp v24, v37, v114 row_newbcast:4 row_mask:0xf bank_mask:0xf
  v_dot2c_f32_bf16_dpp v25, v53, v114 row_newbcast:4 row_mask:0xf bank_mask:0xf
  v_dot2c_f32_bf16_dpp v26, v37, v115 row_newbcast:4 row_mask:0xf bank_mask:0xf
  v_dot2c_f32_bf16_dpp v27, v53, v115 row_newbcast:4 row_mask:0xf bank_mask:0xf
  global_load_dwordx4 v[112:115], v1, s[46:47] offset:2048 nt
  s_waitcnt vmcnt(15)
  v_dot2c_f32_bf16_dpp v20, v37, v116 row_newbcast:12 row_mask:0xf bank_mask:0xf
  v_dot2c_f32_bf16_dpp v21, v53, v116 row_newbcast:12 row_mask:0xf bank_mask:0xf
  v_dot2c_f32_bf16_dpp v22, v37, v117 row_newbcast:12 row_mask:0xf bank_mask:0xf
  v_dot2c_f32_bf16_dpp v23, v53, v117 row_newbcast:12 row_mask:0xf bank_mask:0xf
  v_dot2c_f32_bf16_dpp v24, v37, v118 row_newbcast:12 row_mask:0xf bank_mask:0xf
  v_dot2c_f32_bf16_dpp v25, v53, v118 row_newbcast:12 row_mask:0xf bank_mask:0xf
  v_dot2c_f32_bf16_dpp v26, v37, v119 row_newbcast:12 row_mask:0xf bank_mask:0xf
  v_dot2c_f32_bf16_dpp v27, v53, v119 row_newbcast:12 row_mask:0xf bank_mask:0xf
  global_load_dwordx4 v[116:119], v1, s[46:47] offset:3072 nt
  s_add_u32 s46, s46, 4096
  s_addc_u32 s47, s47, 0
  v_lshlrev_b32 v52, 16, v38
  s_waitcnt vmcnt(15)
  v_dot2c_f32_bf16_dpp v20, v38, v56 row_newbcast:0 row_mask:0xf bank_mask:0xf
  v_dot2c_f32_bf16_dpp v21, v52, v56 row_newbcast:0 row_mask:0xf bank_mask:0xf
  v_dot2c_f32_bf16_dpp v22, v38, v57 row_newbcast:0 row_mask:0xf bank_mask:0xf
  v_dot2c_f32_bf16_dpp v23, v52, v57 row_newbcast:0 row_mask:0xf bank_mask:0xf
  v_dot2c_f32_bf16_dpp v24, v38, v58 row_newbcast:0 row_mask:0xf bank_mask:0xf
  v_dot2c_f32_bf16_dpp v25, v52, v58 row_newbcast:0 row_mask:0xf bank_mask:0xf
  v_dot2c_f32_bf16_dpp v26, v38, v59 row_newbcast:0 row_mask:0xf bank_mask:0xf
  v_dot2c_f32_bf16_dpp v27, v52, v59 row_newbcast:0 row_mask:0xf bank_mask:0xf
  global_load_dwordx4 v[56:59], v1, s[46:47] offset:0 nt
  s_waitcnt vmcnt(15)
  v_dot2c_f32_bf16_dpp v20, v38, v60 row_newbcast:8 row_mask:0xf bank_mask:0xf
  v_dot2c_f32_bf16_dpp v21, v52, v60 row_newbcast:8 row_mask:0xf bank_mask:0xf
  v_dot2c_f32_bf16_dpp v22, v38, v61 row_newbcast:8 row_mask:0xf bank_mask:0xf
  v_dot2c_f32_bf16_dpp v23, v52, v61 row_newbcast:8 row_mask:0xf bank_mask:0xf
  v_dot2c_f32_bf16_dpp v24, v38, v62 row_newbcast:8 row_mask:0xf bank_mask:0xf
  v_dot2c_f32_bf16_dpp v25, v52, v62 row_newbcast:8 row_mask:0xf bank_mask:0xf
  v_dot2c_f32_bf16_dpp v26, v38, v63 row_newbcast:8 row_mask:0xf bank_mask:0xf
  v_dot2c_f32_bf16_dpp v27, v52, v63 row_newbcast:8 row_mask:0xf bank_mask:0xf
  global_load_dwordx4 v[60:63], v1, s[46:47] offset:1024 nt
  s_waitcnt vmcnt(15)
  v_dot2c_f32_bf16_dpp v20, v38, v64 row_newbcast:4 row_mask:0xf bank_mask:0xf
  v_dot2c_f32_bf16_dpp v21, v52, v64 row_newbcast:4 row_mask:0xf bank_mask:0xf
  v_dot2c_f32_bf16_dpp v22, v38, v65 row_newbcast:4 row_mask:0xf bank_mask:0xf
  v_dot2c_f32_bf16_dpp v23, v52, v65 row_newbcast:4 row_mask:0xf bank_mask:0xf
  v_dot2c_f32_bf16_dpp v24, v38, v66 row_newbcast:4 row_mask:0xf bank_mask:0xf
  v_dot2c_f32_bf16_dpp v25, v52, v66 row_newbcast:4 row_mask:0xf bank_mask:0xf
  v_dot2c_f32_bf16_dpp v26, v38, v67 row_newbcast:4 row_mask:0xf bank_mask:0xf
  v_dot2c_f32_bf16_dpp v27, v52, v67 row_newbcast:4 row_mask:0xf bank_mask:0xf
  global_load_dwordx4 v[64:67], v1, s[46:47] offset:2048 nt
  s_waitcnt vmcnt(15)
  v_dot2c_f32_bf16_dpp v20, v38, v68 row_newbcast:12 row_mask:0xf bank_mask:0xf
  v_dot2c_f32_bf16_dpp v21, v52, v68 row_newbcast:12 row_mask:0xf bank_mask:0xf
  v_dot2c_f32_bf16_dpp v22, v38, v69 row_newbcast:12 row_mask:0xf bank_mask:0xf
  v_dot2c_f32_bf16_dpp v23, v52, v69 row_newbcast:12 row_mask:0xf bank_mask:0xf
  v_dot2c_f32_bf16_dpp v24, v38, v70 row_newbcast:12 row_mask:0xf bank_mask:0xf
  v_dot2c_f32_bf16_dpp v25, v52, v70 row_newbcast:12 row_mask:0xf bank_mask:0xf
  v_dot2c_f32_bf16_dpp v26, v38, v71 row_newbcast:12 row_mask:0xf bank_mask:0xf
  v_dot2c_f32_bf16_dpp v27, v52, v71 row_newbcast:12 row_mask:0xf bank_mask:0xf
  global_load_dwordx4 v[68:71], v1, s[46:47] offset:3072 nt
  s_add_u32 s46, s46, 4096
  s_addc_u32 s47, s47, 0
  v_lshlrev_b32 v53, 16, v39
  s_waitcnt vmcnt(15)
  v_dot2c_f32_bf16_dpp v20, v39, v72 row_newbcast:0 row_mask:0xf bank_mask:0xf
  v_dot2c_f32_bf16_dpp v21, v53, v72 row_newbcast:0 row_mask:0xf bank_mask:0xf
  v_dot2c_f32_bf16_dpp v22, v39, v73 row_newbcast:0 row_mask:0xf bank_mask:0xf
  v_dot2c_f32_bf16_dpp v23, v53, v73 row_newbcast:0 row_mask:0xf bank_mask:0xf
  v_dot2c_f32_bf16_dpp v24, v39, v74 row_newbcast:0 row_mask:0xf bank_mask:0xf
  v_dot2c_f32_bf16_dpp v25, v53, v74 row_newbcast:0 row_mask:0xf bank_mask:0xf
  v_dot2c_f32_bf16_dpp v26, v39, v75 row_newbcast:0 row_mask:0xf bank_mask:0xf
  v_dot2c_f32_bf16_dpp v27, v53, v75 row_newbcast:0 row_mask:0xf bank_mask:0xf
  global_load_dwordx4 v[72:75], v1, s[46:47] offset:0 nt
  s_waitcnt vmcnt(15)
  v_dot2c_f32_bf16_dpp v20, v39, v76 row_newbcast:8 row_mask:0xf bank_mask:0xf
  v_dot2c_f32_bf16_dpp v21, v53, v76 row_newbcast:8 row_mask:0xf bank_mask:0xf
  v_dot2c_f32_bf16_dpp v22, v39, v77 row_newbcast:8 row_mask:0xf bank_mask:0xf
  v_dot2c_f32_bf16_dpp v23, v53, v77 row_newbcast:8 row_mask:0xf bank_mask:0xf
  v_dot2c_f32_bf16_dpp v24, v39, v78 row_newbcast:8 row_mask:0xf bank_mask:0xf
  v_dot2c_f32_bf16_dpp v25, v53, v78 row_newbcast:8 row_mask:0xf bank_mask:0xf
  v_dot2c_f32_bf16_dpp v26, v39, v79 row_newbcast:8 row_mask:0xf bank_mask:0xf
  v_dot2c_f32_bf16_dpp v27, v53, v79 row_newbcast:8 row_mask:0xf bank_mask:0xf
  global_load_dwordx4 v[76:79], v1, s[46:47] offset:1024 nt
  s_waitcnt vmcnt(15)
  v_dot2c_f32_bf16_dpp v20, v39, v80 row_newbcast:4 row_mask:0xf bank_mask:0xf
  v_dot2c_f32_bf16_dpp v21, v53, v80 row_newbcast:4 row_mask:0xf bank_mask:0xf
  v_dot2c_f32_bf16_dpp v22, v39, v81 row_newbcast:4 row_mask:0xf bank_mask:0xf
  v_dot2c_f32_bf16_dpp v23, v53, v81 row_newbcast:4 row_mask:0xf bank_mask:0xf
  v_dot2c_f32_bf16_dpp v24, v39, v82 row_newbcast:4 row_mask:0xf bank_mask:0xf
  v_dot2c_f32_bf16_dpp v25, v53, v82 row_newbcast:4 row_mask:0xf bank_mask:0xf
  v_dot2c_f32_bf16_dpp v26, v39, v83 row_newbcast:4 row_mask:0xf bank_mask:0xf
  v_dot2c_f32_bf16_dpp v27, v53, v83 row_newbcast:4 row_mask:0xf bank_mask:0xf
  global_load_dwordx4 v[80:83], v1, s[46:47] offset:2048 nt
  s_waitcnt vmcnt(15)
  v_dot2c_f32_bf16_dpp v20, v39, v84 row_newbcast:12 row_mask:0xf bank_mask:0xf
  v_dot2c_f32_bf16_dpp v21, v53, v84 row_newbcast:12 row_mask:0xf bank_mask:0xf
  v_dot2c_f32_bf16_dpp v22, v39, v85 row_newbcast:12 row_mask:0xf bank_mask:0xf
  v_dot2c_f32_bf16_dpp v23, v53, v85 row_newbcast:12 row_mask:0xf bank_mask:0xf
  v_dot2c_f32_bf16_dpp v24, v39, v86 row_newbcast:12 row_mask:0xf bank_mask:0xf
  v_dot2c_f32_bf16_dpp v25, v53, v86 row_newbcast:12 row_mask:0xf bank_mask:0xf
  v_dot2c_f32_bf16_dpp v26, v39, v87 row_newbcast:12 row_mask:0xf bank_mask:0xf
  v_dot2c_f32_bf16_dpp v27, v53, v87 row_newbcast:12 row_mask:0xf bank_mask:0xf
  global_load_dwordx4 v[84:87], v1, s[46:47] offset:3072 nt
  s_add_u32 s46, s46, 4096
  s_addc_u32 s47, s47, 0
  v_lshlrev_b32 v52, 16, v40
  s_waitcnt vmcnt(15)
  v_dot2c_f32_bf16_dpp v20, v40, v88 row_newbcast:0 row_mask:0xf bank_mask:0xf
  v_dot2c_f32_bf16_dpp v21, v52, v88 row_newbcast:0 row_mask:0xf bank_mask:0xf
  v_dot2c_f32_bf16_dpp v22, v40, v89 row_newbcast:0 row_mask:0xf bank_mask:0xf
  v_dot2c_f32_bf16_dpp v23, v52, v89 row_newbcast:0 row_mask:0xf bank_mask:0xf
  v_dot2c_f32_bf16_dpp v24, v40, v90 row_newbcast:0 row_mask:0xf bank_mask:0xf
  v_dot2c_f32_bf16_dpp v25, v52, v90 row_newbcast:0 row_mask:0xf bank_mask:0xf
  v_dot2c_f32_bf16_dpp v26, v40, v91 row_newbcast:0 row_mask:0xf bank_mask:0xf
  v_dot2c_f32_bf16_dpp v27, v52, v91 row_newbcast:0 row_mask:0xf bank_mask:0xf
  global_load_dwordx4 v[88:91], v1, s[46:47] offset:0 nt
  s_waitcnt vmcnt(15)
  v_dot2c_f32_bf16_dpp v20, v40, v92 row_newbcast:8 row_mask:0xf bank_mask:0xf
  v_dot2c_f32_bf16_dpp v21, v52, v92 row_newbcast:8 row_mask:0xf bank_mask:0xf
  v_dot2c_f32_bf16_dpp v22, v40, v93 row_newbcast:8 row_mask:0xf bank_mask:0xf
  v_dot2c_f32_bf16_dpp v23, v52, v93 row_newbcast:8 row_mask:0xf bank_mask:0xf
  v_dot2c_f32_bf16_dpp v24, v40, v94 row_newbcast:8 row_mask:0xf bank_mask:0xf
  v_dot2c_f32_bf16_dpp v25, v52, v94 row_newbcast:8 row_mask:0xf bank_mask:0xf
  v_dot2c_f32_bf16_dpp v26, v40, v95 row_newbcast:8 row_mask:0xf bank_mask:0xf
  v_dot2c_f32_bf16_dpp v27, v52, v95 row_newbcast:8 row_mask:0xf bank_mask:0xf
  global_load_dwordx4 v[92:95], v1, s[46:47] offset:1024 nt
  s_waitcnt vmcnt(15)
  v_dot2c_f32_bf16_dpp v20, v40, v96 row_newbcast:4 row_mask:0xf bank_mask:0xf
  v_dot2c_f32_bf16_dpp v21, v52, v96 row_newbcast:4 row_mask:0xf bank_mask:0xf
  v_dot2c_f32_bf16_dpp v22, v40, v97 row_newbcast:4 row_mask:0xf bank_mask:0xf
  v_dot2c_f32_bf16_dpp v23, v52, v97 row_newbcast:4 row_mask:0xf bank_mask:0xf
  v_dot2c_f32_bf16_dpp v24, v40, v98 row_newbcast:4 row_mask:0xf bank_mask:0xf
  v_dot2c_f32_bf16_dpp v25, v52, v98 row_newbcast:4 row_mask:0xf bank_mask:0xf
  v_dot2c_f32_bf16_dpp v26, v40, v99 row_newbcast:4 row_mask:0xf bank_mask:0xf
  v_dot2c_f32_bf16_dpp v27, v52, v99 row_newbcast:4 row_mask:0xf bank_mask:0xf
  global_load_dwordx4 v[96:99], v1, s[46:47] offset:2048 nt
  s_waitcnt vmcnt(15)
  v_dot2c_f32_bf16_dpp v20, v40, v100 row_newbcast:12 row_mask:0xf bank_mask:0xf
  v_dot2c_f32_bf16_dpp v21, v52, v100 row_newbcast:12 row_mask:0xf bank_mask:0xf
  v_dot2c_f32_bf16_dpp v22, v40, v101 row_newbcast:12 row_mask:0xf bank_mask:0xf
  v_dot2c_f32_bf16_dpp v23, v52, v101 row_newbcast:12 row_mask:0xf bank_mask:0xf
  v_dot2c_f32_bf16_dpp v24, v40, v102 row_newbcast:12 row_mask:0xf bank_mask:0xf
  v_dot2c_f32_bf16_dpp v25, v52, v102 row_newbcast:12 row_mask:0xf bank_mask:0xf
  v_dot2c_f32_bf16_dpp v26, v40, v103 row_newbcast:12 row_mask:0xf bank_mask:0xf
  v_dot2c_f32_bf16_dpp v27, v52, v103 row_newbcast:12 row_mask:0xf bank_mask:0xf
  global_load_dwordx4 v[100:103], v1, s[46:47] offset:3072 nt
  s_add_u32 s46, s46, 4096
  s_addc_u32 s47, s47, 0
  v_lshlrev_b32 v53, 16, v41
  s_waitcnt vmcnt(15)
  v_dot2c_f32_bf16_dpp v20, v41, v104 row_newbcast:0 row_mask:0xf bank_mask:0xf
  v_dot2c_f32_bf16_dpp v21, v53, v104 row_newbcast:0 row_mask:0xf bank_mask:0xf
  v_dot2c_f32_bf16_dpp v22, v41, v105 row_newbcast:0 row_mask:0xf bank_mask:0xf
  v_dot2c_f32_bf16_dpp v23, v53, v105 row_newbcast:0 row_mask:0xf bank_mask:0xf
  v_dot2c_f32_bf16_dpp v24, v41, v106 row_newbcast:0 row_mask:0xf bank_mask:0xf
  v_dot2c_f32_bf16_dpp v25, v53, v106 row_newbcast:0 row_mask:0xf bank_mask:0xf
  v_dot2c_f32_bf16_dpp v26, v41, v107 row_newbcast:0 row_mask:0xf bank_mask:0xf
  v_dot2c_f32_bf16_dpp v27, v53, v107 row_newbcast:0 row_mask:0xf bank_mask:0xf
  global_load_dwordx4 v[104:107], v1, s[46:47] offset:0 nt
  s_waitcnt vmcnt(15)
  v_dot2c_f32_bf16_dpp v20, v41, v108 row_newbcast:8 row_mask:0xf bank_mask:0xf
  v_dot2c_f32_bf16_dpp v21, v53, v108 row_newbcast:8 row_mask:0xf bank_mask:0xf
  v_dot2c_f32_bf16_dpp v22, v41, v109 row_newbcast:8 row_mask:0xf bank_mask:0xf
  v_dot2c_f32_bf16_dpp v23, v53, v109 row_newbcast:8 row_mask:0xf bank_mask:0xf
  v_dot2c_f32_bf16_dpp v24, v41, v110 row_newbcast:8 row_mask:0xf bank_mask:0xf
  v_dot2c_f32_bf16_dpp v25, v53, v110 row_newbcast:8 row_mask:0xf bank_mask:0xf
  v_dot2c_f32_bf16_dpp v26, v41, v111 row_newbcast:8 row_mask:0xf bank_mask:0xf
  v_dot2c_f32_bf16_dpp v27, v53, v111 row_newbcast:8 row_mask:0xf bank_mask:0xf
  global_load_dwordx4 v[108:111], v1, s[46:47] offset:1024 nt
  s_waitcnt vmcnt(15)
  v_dot2c_f32_bf16_dpp v20, v41, v112 row_newbcast:4 row_mask:0xf bank_mask:0xf
  v_dot2c_f32_bf16_dpp v21, v53, v112 row_newbcast:4 row_mask:0xf bank_mask:0xf
  v_dot2c_f32_bf16_dpp v22, v41, v113 row_newbcast:4 row_mask:0xf bank_mask:0xf
  v_dot2c_f32_bf16_dpp v23, v53, v113 row_newbcast:4 row_mask:0xf bank_mask:0xf
  v_dot2c_f32_bf16_dpp v24, v41, v114 row_newbcast:4 row_mask:0xf bank_mask:0xf
  v_dot2c_f32_bf16_dpp v25, v53, v114 row_newbcast:4 row_mask:0xf bank_mask:0xf
  v_dot2c_f32_bf16_dpp v26, v41, v115 row_newbcast:4 row_mask:0xf bank_mask:0xf
  v_dot2c_f32_bf16_dpp v27, v53, v115 row_newbcast:4 row_mask:0xf bank_mask:0xf
  global_load_dwordx4 v[112:115], v1, s[46:47] offset:2048 nt
  s_waitcnt vmcnt(15)
  v_dot2c_f32_bf16_dpp v20, v41, v116 row_newbcast:12 row_mask:0xf bank_mask:0xf
  v_dot2c_f32_bf16_dpp v21, v53, v116 row_newbcast:12 row_mask:0xf bank_mask:0xf
  v_dot2c_f32_bf16_dpp v22, v41, v117 row_newbcast:12 row_mask:0xf bank_mask:0xf
  v_dot2c_f32_bf16_dpp v23, v53, v117 row_newbcast:12 row_mask:0xf bank_mask:0xf
  v_dot2c_f32_bf16_dpp v24, v41, v118 row_newbcast:12 row_mask:0xf bank_mask:0xf
  v_dot2c_f32_bf16_dpp v25, v53, v118 row_newbcast:12 row_mask:0xf bank_mask:0xf
  v_dot2c_f32_bf16_dpp v26, v41, v119 row_newbcast:12 row_mask:0xf bank_mask:0xf
  v_dot2c_f32_bf16_dpp v27, v53, v119 row_newbcast:12 row_mask:0xf bank_mask:0xf
  global_load_dwordx4 v[116:119], v1, s[46:47] offset:3072 nt
  s_add_u32 s46, s46, 4096
  s_addc_u32 s47, s47, 0
  v_lshlrev_b32 v52, 16, v42
  s_waitcnt vmcnt(15)
  v_dot2c_f32_bf16_dpp v20, v42, v56 row_newbcast:0 row_mask:0xf bank_mask:0xf
  v_dot2c_f32_bf16_dpp v21, v52, v56 row_newbcast:0 row_mask:0xf bank_mask:0xf
  v_dot2c_f32_bf16_dpp v22, v42, v57 row_newbcast:0 row_mask:0xf bank_mask:0xf
  v_dot2c_f32_bf16_dpp v23, v52, v57 row_newbcast:0 row_mask:0xf bank_mask:0xf
  v_dot2c_f32_bf16_dpp v24, v42, v58 row_newbcast:0 row_mask:0xf bank_mask:0xf
  v_dot2c_f32_bf16_dpp v25, v52, v58 row_newbcast:0 row_mask:0xf bank_mask:0xf
  v_dot2c_f32_bf16_dpp v26, v42, v59 row_newbcast:0 row_mask:0xf bank_mask:0xf
  v_dot2c_f32_bf16_dpp v27, v52, v59 row_newbcast:0 row_mask:0xf bank_mask:0xf
  global_load_dwordx4 v[56:59], v1, s[46:47] offset:0 nt
  s_waitcnt vmcnt(15)
  v_dot2c_f32_bf16_dpp v20, v42, v60 row_newbcast:8 row_mask:0xf bank_mask:0xf
  v_dot2c_f32_bf16_dpp v21, v52, v60 row_newbcast:8 row_mask:0xf bank_mask:0xf
  v_dot2c_f32_bf16_dpp v22, v42, v61 row_newbcast:8 row_mask:0xf bank_mask:0xf
  v_dot2c_f32_bf16_dpp v23, v52, v61 row_newbcast:8 row_mask:0xf bank_mask:0xf
  v_dot2c_f32_bf16_dpp v24, v42, v62 row_newbcast:8 row_mask:0xf bank_mask:0xf
  v_dot2c_f32_bf16_dpp v25, v52, v62 row_newbcast:8 row_mask:0xf bank_mask:0xf
  v_dot2c_f32_bf16_dpp v26, v42, v63 row_newbcast:8 row_mask:0xf bank_mask:0xf
  v_dot2c_f32_bf16_dpp v27, v52, v63 row_newbcast:8 row_mask:0xf bank_mask:0xf
  global_load_dwordx4 v[60:63], v1, s[46:47] offset:1024 nt
  s_waitcnt vmcnt(15)
  v_dot2c_f32_bf16_dpp v20, v42, v64 row_newbcast:4 row_mask:0xf bank_mask:0xf
  v_dot2c_f32_bf16_dpp v21, v52, v64 row_newbcast:4 row_mask:0xf bank_mask:0xf
  v_dot2c_f32_bf16_dpp v22, v42, v65 row_newbcast:4 row_mask:0xf bank_mask:0xf
  v_dot2c_f32_bf16_dpp v23, v52, v65 row_newbcast:4 row_mask:0xf bank_mask:0xf
  v_dot2c_f32_bf16_dpp v24, v42, v66 row_newbcast:4 row_mask:0xf bank_mask:0xf
  v_dot2c_f32_bf16_dpp v25, v52, v66 row_newbcast:4 row_mask:0xf bank_mask:0xf
  v_dot2c_f32_bf16_dpp v26, v42, v67 row_newbcast:4 row_mask:0xf bank_mask:0xf
  v_dot2c_f32_bf16_dpp v27, v52, v67 row_newbcast:4 row_mask:0xf bank_mask:0xf
  global_load_dwordx4 v[64:67], v1, s[46:47] offset:2048 nt
  s_waitcnt vmcnt(15)
  v_dot2c_f32_bf16_dpp v20, v42, v68 row_newbcast:12 row_mask:0xf bank_mask:0xf
  v_dot2c_f32_bf16_dpp v21, v52, v68 row_newbcast:12 row_mask:0xf bank_mask:0xf
  v_dot2c_f32_bf16_dpp v22, v42, v69 row_newbcast:12 row_mask:0xf bank_mask:0xf
  v_dot2c_f32_bf16_dpp v23, v52, v69 row_newbcast:12 row_mask:0xf bank_mask:0xf
  v_dot2c_f32_bf16_dpp v24, v42, v70 row_newbcast:12 row_mask:0xf bank_mask:0xf
  v_dot2c_f32_bf16_dpp v25, v52, v70 row_newbcast:12 row_mask:0xf bank_mask:0xf
  v_dot2c_f32_bf16_dpp v26, v42, v71 row_newbcast:12 row_mask:0xf bank_mask:0xf
  v_dot2c_f32_bf16_dpp v27, v52, v71 row_newbcast:12 row_mask:0xf bank_mask:0xf
  global_load_dwordx4 v[68:71], v1, s[46:47] offset:3072 nt
  s_add_u32 s46, s46, 4096
  s_addc_u32 s47, s47, 0
  v_lshlrev_b32 v53, 16, v43
  s_waitcnt vmcnt(15)
  v_dot2c_f32_bf16_dpp v20, v43, v72 row_newbcast:0 row_mask:0xf bank_mask:0xf
  v_dot2c_f32_bf16_dpp v21, v53, v72 row_newbcast:0 row_mask:0xf bank_mask:0xf
  v_dot2c_f32_bf16_dpp v22, v43, v73 row_newbcast:0 row_mask:0xf bank_mask:0xf
  v_dot2c_f32_bf16_dpp v23, v53, v73 row_newbcast:0 row_mask:0xf bank_mask:0xf
  v_dot2c_f32_bf16_dpp v24, v43, v74 row_newbcast:0 row_mask:0xf bank_mask:0xf
  v_dot2c_f32_bf16_dpp v25, v53, v74 row_newbcast:0 row_mask:0xf bank_mask:0xf
  v_dot2c_f32_bf16_dpp v26, v43, v75 row_newbcast:0 row_mask:0xf bank_mask:0xf
  v_dot2c_f32_bf16_dpp v27, v53, v75 row_newbcast:0 row_mask:0xf bank_mask:0xf
  global_load_dwordx4 v[72:75], v1, s[46:47] offset:0 nt
  s_waitcnt vmcnt(15)
  v_dot2c_f32_bf16_dpp v20, v43, v76 row_newbcast:8 row_mask:0xf bank_mask:0xf
  v_dot2c_f32_bf16_dpp v21, v53, v76 row_newbcast:8 row_mask:0xf bank_mask:0xf
  v_dot2c_f32_bf16_dpp v22, v43, v77 row_newbcast:8 row_mask:0xf bank_mask:0xf
  v_dot2c_f32_bf16_dpp v23, v53, v77 row_newbcast:8 row_mask:0xf bank_mask:0xf
  v_dot2c_f32_bf16_dpp v24, v43, v78 row_newbcast:8 row_mask:0xf bank_mask:0xf
  v_dot2c_f32_bf16_dpp v25, v53, v78 row_newbcast:8 row_mask:0xf bank_mask:0xf
  v_dot2c_f32_bf16_dpp v26, v43, v79 row_newbcast:8 row_mask:0xf bank_mask:0xf
  v_dot2c_f32_bf16_dpp v27, v53, v79 row_newbcast:8 row_mask:0xf bank_mask:0xf
  global_load_dwordx4 v[76:79], v1, s[46:47] offset:1024 nt
  s_waitcnt vmcnt(15)
  v_dot2c_f32_bf16_dpp v20, v43, v80 row_newbcast:4 row_mask:0xf bank_mask:0xf
  v_dot2c_f32_bf16_dpp v21, v53, v80 row_newbcast:4 row_mask:0xf bank_mask:0xf
  v_dot2c_f32_bf16_dpp v22, v43, v81 row_newbcast:4 row_mask:0xf bank_mask:0xf
  v_dot2c_f32_bf16_dpp v23, v53, v81 row_newbcast:4 row_mask:0xf bank_mask:0xf
  v_dot2c_f32_bf16_dpp v24, v43, v82 row_newbcast:4 row_mask:0xf bank_mask:0xf
  v_dot2c_f32_bf16_dpp v25, v53, v82 row_newbcast:4 row_mask:0xf bank_mask:0xf
  v_dot2c_f32_bf16_dpp v26, v43, v83 row_newbcast:4 row_mask:0xf bank_mask:0xf
  v_dot2c_f32_bf16_dpp v27, v53, v83 row_newbcast:4 row_mask:0xf bank_mask:0xf
  global_load_dwordx4 v[80:83], v1, s[46:47] offset:2048 nt
  s_waitcnt vmcnt(15)
  v_dot2c_f32_bf16_dpp v20, v43, v84 row_newbcast:12 row_mask:0xf bank_mask:0xf
  v_dot2c_f32_bf16_dpp v21, v53, v84 row_newbcast:12 row_mask:0xf bank_mask:0xf
  v_dot2c_f32_bf16_dpp v22, v43, v85 row_newbcast:12 row_mask:0xf bank_mask:0xf
  v_dot2c_f32_bf16_dpp v23, v53, v85 row_newbcast:12 row_mask:0xf bank_mask:0xf
  v_dot2c_f32_bf16_dpp v24, v43, v86 row_newbcast:12 row_mask:0xf bank_mask:0xf
  v_dot2c_f32_bf16_dpp v25, v53, v86 row_newbcast:12 row_mask:0xf bank_mask:0xf
  v_dot2c_f32_bf16_dpp v26, v43, v87 row_newbcast:12 row_mask:0xf bank_mask:0xf
  v_dot2c_f32_bf16_dpp v27, v53, v87 row_newbcast:12 row_mask:0xf bank_mask:0xf
  global_load_dwordx4 v[84:87], v1, s[46:47] offset:3072 nt
  s_add_u32 s46, s46, 4096
  s_addc_u32 s47, s47, 0
  v_lshlrev_b32 v52, 16, v44
  s_waitcnt vmcnt(15)
  v_dot2c_f32_bf16_dpp v20, v44, v88 row_newbcast:0 row_mask:0xf bank_mask:0xf
  v_dot2c_f32_bf16_dpp v21, v52, v88 row_newbcast:0 row_mask:0xf bank_mask:0xf
  v_dot2c_f32_bf16_dpp v22, v44, v89 row_newbcast:0 row_mask:0xf bank_mask:0xf
  v_dot2c_f32_bf16_dpp v23, v52, v89 row_newbcast:0 row_mask:0xf bank_mask:0xf
  v_dot2c_f32_bf16_dpp v24, v44, v90 row_newbcast:0 row_mask:0xf bank_mask:0xf
  v_dot2c_f32_bf16_dpp v25, v52, v90 row_newbcast:0 row_mask:0xf bank_mask:0xf
  v_dot2c_f32_bf16_dpp v26, v44, v91 row_newbcast:0 row_mask:0xf bank_mask:0xf
  v_dot2c_f32_bf16_dpp v27, v52, v91 row_newbcast:0 row_mask:0xf bank_mask:0xf
  global_load_dwordx4 v[88:91], v1, s[46:47] offset:0 nt
  s_waitcnt vmcnt(15)
  v_dot2c_f32_bf16_dpp v20, v44, v92 row_newbcast:8 row_mask:0xf bank_mask:0xf
  v_dot2c_f32_bf16_dpp v21, v52, v92 row_newbcast:8 row_mask:0xf bank_mask:0xf
  v_dot2c_f32_bf16_dpp v22, v44, v93 row_newbcast:8 row_mask:0xf bank_mask:0xf
  v_dot2c_f32_bf16_dpp v23, v52, v93 row_newbcast:8 row_mask:0xf bank_mask:0xf
  v_dot2c_f32_bf16_dpp v24, v44, v94 row_newbcast:8 row_mask:0xf bank_mask:0xf
  v_dot2c_f32_bf16_dpp v25, v52, v94 row_newbcast:8 row_mask:0xf bank_mask:0xf
  v_dot2c_f32_bf16_dpp v26, v44, v95 row_newbcast:8 row_mask:0xf bank_mask:0xf
  v_dot2c_f32_bf16_dpp v27, v52, v95 row_newbcast:8 row_mask:0xf bank_mask:0xf
  global_load_dwordx4 v[92:95], v1, s[46:47] offset:1024 nt
  s_waitcnt vmcnt(15)
  v_dot2c_f32_bf16_dpp v20, v44, v96 row_newbcast:4 row_mask:0xf bank_mask:0xf
  v_dot2c_f32_bf16_dpp v21, v52, v96 row_newbcast:4 row_mask:0xf bank_mask:0xf
  v_dot2c_f32_bf16_dpp v22, v44, v97 row_newbcast:4 row_mask:0xf bank_mask:0xf
  v_dot2c_f32_bf16_dpp v23, v52, v97 row_newbcast:4 row_mask:0xf bank_mask:0xf
  v_dot2c_f32_bf16_dpp v24, v44, v98 row_newbcast:4 row_mask:0xf bank_mask:0xf
  v_dot2c_f32_bf16_dpp v25, v52, v98 row_newbcast:4 row_mask:0xf bank_mask:0xf
  v_dot2c_f32_bf16_dpp v26, v44, v99 row_newbcast:4 row_mask:0xf bank_mask:0xf
  v_dot2c_f32_bf16_dpp v27, v52, v99 row_newbcast:4 row_mask:0xf bank_mask:0xf
  global_load_dwordx4 v[96:99], v1, s[46:47] offset:2048 nt
  s_waitcnt vmcnt(15)
  v_dot2c_f32_bf16_dpp v20, v44, v100 row_newbcast:12 row_mask:0xf bank_mask:0xf
  v_dot2c_f32_bf16_dpp v21, v52, v100 row_newbcast:12 row_mask:0xf bank_mask:0xf
  v_dot2c_f32_bf16_dpp v22, v44, v101 row_newbcast:12 row_mask:0xf bank_mask:0xf
  v_dot2c_f32_bf16_dpp v23, v52, v101 row_newbcast:12 row_mask:0xf bank_mask:0xf
  v_dot2c_f32_bf16_dpp v24, v44, v102 row_newbcast:12 row_mask:0xf bank_mask:0xf
  v_dot2c_f32_bf16_dpp v25, v52, v102 row_newbcast:12 row_mask:0xf bank_mask:0xf
  v_dot2c_f32_bf16_dpp v26, v44, v103 row_newbcast:12 row_mask:0xf bank_mask:0xf
  v_dot2c_f32_bf16_dpp v27, v52, v103 row_newbcast:12 row_mask:0xf bank_mask:0xf
  global_load_dwordx4 v[100:103], v1, s[46:47] offset:3072 nt
  s_add_u32 s46, s46, 4096
  s_addc_u32 s47, s47, 0
  v_lshlrev_b32 v53, 16, v45
  s_waitcnt vmcnt(15)
  v_dot2c_f32_bf16_dpp v20, v45, v104 row_newbcast:0 row_mask:0xf bank_mask:0xf
  v_dot2c_f32_bf16_dpp v21, v53, v104 row_newbcast:0 row_mask:0xf bank_mask:0xf
  v_dot2c_f32_bf16_dpp v22, v45, v105 row_newbcast:0 row_mask:0xf bank_mask:0xf
  v_dot2c_f32_bf16_dpp v23, v53, v105 row_newbcast:0 row_mask:0xf bank_mask:0xf
  v_dot2c_f32_bf16_dpp v24, v45, v106 row_newbcast:0 row_mask:0xf bank_mask:0xf
  v_dot2c_f32_bf16_dpp v25, v53, v106 row_newbcast:0 row_mask:0xf bank_mask:0xf
  v_dot2c_f32_bf16_dpp v26, v45, v107 row_newbcast:0 row_mask:0xf bank_mask:0xf
  v_dot2c_f32_bf16_dpp v27, v53, v107 row_newbcast:0 row_mask:0xf bank_mask:0xf
  global_load_dwordx4 v[104:107], v1, s[46:47] offset:0 nt
  s_waitcnt vmcnt(15)
  v_dot2c_f32_bf16_dpp v20, v45, v108 row_newbcast:8 row_mask:0xf bank_mask:0xf
  v_dot2c_f32_bf16_dpp v21, v53, v108 row_newbcast:8 row_mask:0xf bank_mask:0xf
  v_dot2c_f32_bf16_dpp v22, v45, v109 row_newbcast:8 row_mask:0xf bank_mask:0xf
  v_dot2c_f32_bf16_dpp v23, v53, v109 row_newbcast:8 row_mask:0xf bank_mask:0xf
  v_dot2c_f32_bf16_dpp v24, v45, v110 row_newbcast:8 row_mask:0xf bank_mask:0xf
  v_dot2c_f32_bf16_dpp v25, v53, v110 row_newbcast:8 row_mask:0xf bank_mask:0xf
  v_dot2c_f32_bf16_dpp v26, v45, v111 row_newbcast:8 row_mask:0xf bank_mask:0xf
  v_dot2c_f32_bf16_dpp v27, v53, v111 row_newbcast:8 row_mask:0xf bank_mask:0xf
  global_load_dwordx4 v[108:111], v1, s[46:47] offset:1024 nt
  s_waitcnt vmcnt(15)
  v_dot2c_f32_bf16_dpp v20, v45, v112 row_newbcast:4 row_mask:0xf bank_mask:0xf
  v_dot2c_f32_bf16_dpp v21, v53, v112 row_newbcast:4 row_mask:0xf bank_mask:0xf
  v_dot2c_f32_bf16_dpp v22, v45, v113 row_newbcast:4 row_mask:0xf bank_mask:0xf
  v_dot2c_f32_bf16_dpp v23, v53, v113 row_newbcast:4 row_mask:0xf bank_mask:0xf
  v_dot2c_f32_bf16_dpp v24, v45, v114 row_newbcast:4 row_mask:0xf bank_mask:0xf
  v_dot2c_f32_bf16_dpp v25, v53, v114 row_newbcast:4 row_mask:0xf bank_mask:0xf
  v_dot2c_f32_bf16_dpp v26, v45, v115 row_newbcast:4 row_mask:0xf bank_mask:0xf
  v_dot2c_f32_bf16_dpp v27, v53, v115 row_newbcast:4 row_mask:0xf bank_mask:0xf
  global_load_dwordx4 v[112:115], v1, s[46:47] offset:2048 nt
  s_waitcnt vmcnt(15)
  v_dot2c_f32_bf16_dpp v20, v45, v116 row_newbcast:12 row_mask:0xf bank_mask:0xf
  v_dot2c_f32_bf16_dpp v21, v53, v116 row_newbcast:12 row_mask:0xf bank_mask:0xf
  v_dot2c_f32_bf16_dpp v22, v45, v117 row_newbcast:12 row_mask:0xf bank_mask:0xf
  v_dot2c_f32_bf16_dpp v23, v53, v117 row_newbcast:12 row_mask:0xf bank_mask:0xf
  v_dot2c_f32_bf16_dpp v24, v45, v118 row_newbcast:12 row_mask:0xf bank_mask:0xf
  v_dot2c_f32_bf16_dpp v25, v53, v118 row_newbcast:12 row_mask:0xf bank_mask:0xf
  v_dot2c_f32_bf16_dpp v26, v45, v119 row_newbcast:12 row_mask:0xf bank_mask:0xf
  v_dot2c_f32_bf16_dpp v27, v53, v119 row_newbcast:12 row_mask:0xf bank_mask:0xf
  global_load_dwordx4 v[116:119], v1, s[46:47] offset:3072 nt
  s_add_u32 s46, s46, 4096
  s_addc_u32 s47, s47, 0
  v_lshlrev_b32 v52, 16, v46
  s_waitcnt vmcnt(15)
  v_dot2c_f32_bf16_dpp v20, v46, v56 row_newbcast:0 row_mask:0xf bank_mask:0xf
  v_dot2c_f32_bf16_dpp v21, v52, v56 row_newbcast:0 row_mask:0xf bank_mask:0xf
  v_dot2c_f32_bf16_dpp v22, v46, v57 row_newbcast:0 row_mask:0xf bank_mask:0xf
  v_dot2c_f32_bf16_dpp v23, v52, v57 row_newbcast:0 row_mask:0xf bank_mask:0xf
  v_dot2c_f32_bf16_dpp v24, v46, v58 row_newbcast:0 row_mask:0xf bank_mask:0xf
  v_dot2c_f32_bf16_dpp v25, v52, v58 row_newbcast:0 row_mask:0xf bank_mask:0xf
  v_dot2c_f32_bf16_dpp v26, v46, v59 row_newbcast:0 row_mask:0xf bank_mask:0xf
  v_dot2c_f32_bf16_dpp v27, v52, v59 row_newbcast:0 row_mask:0xf bank_mask:0xf
  global_load_dwordx4 v[56:59], v1, s[46:47] offset:0 nt
  s_waitcnt vmcnt(15)
  v_dot2c_f32_bf16_dpp v20, v46, v60 row_newbcast:8 row_mask:0xf bank_mask:0xf
  v_dot2c_f32_bf16_dpp v21, v52, v60 row_newbcast:8 row_mask:0xf bank_mask:0xf
  v_dot2c_f32_bf16_dpp v22, v46, v61 row_newbcast:8 row_mask:0xf bank_mask:0xf
  v_dot2c_f32_bf16_dpp v23, v52, v61 row_newbcast:8 row_mask:0xf bank_mask:0xf
  v_dot2c_f32_bf16_dpp v24, v46, v62 row_newbcast:8 row_mask:0xf bank_mask:0xf
  v_dot2c_f32_bf16_dpp v25, v52, v62 row_newbcast:8 row_mask:0xf bank_mask:0xf
  v_dot2c_f32_bf16_dpp v26, v46, v63 row_newbcast:8 row_mask:0xf bank_mask:0xf
  v_dot2c_f32_bf16_dpp v27, v52, v63 row_newbcast:8 row_mask:0xf bank_mask:0xf
  global_load_dwordx4 v[60:63], v1, s[46:47] offset:1024 nt
  s_waitcnt vmcnt(15)
  v_dot2c_f32_bf16_dpp v20, v46, v64 row_newbcast:4 row_mask:0xf bank_mask:0xf
  v_dot2c_f32_bf16_dpp v21, v52, v64 row_newbcast:4 row_mask:0xf bank_mask:0xf
  v_dot2c_f32_bf16_dpp v22, v46, v65 row_newbcast:4 row_mask:0xf bank_mask:0xf
  v_dot2c_f32_bf16_dpp v23, v52, v65 row_newbcast:4 row_mask:0xf bank_mask:0xf
  v_dot2c_f32_bf16_dpp v24, v46, v66 row_newbcast:4 row_mask:0xf bank_mask:0xf
  v_dot2c_f32_bf16_dpp v25, v52, v66 row_newbcast:4 row_mask:0xf bank_mask:0xf
  v_dot2c_f32_bf16_dpp v26, v46, v67 row_newbcast:4 row_mask:0xf bank_mask:0xf
  v_dot2c_f32_bf16_dpp v27, v52, v67 row_newbcast:4 row_mask:0xf bank_mask:0xf
  global_load_dwordx4 v[64:67], v1, s[46:47] offset:2048 nt
  s_waitcnt vmcnt(15)
  v_dot2c_f32_bf16_dpp v20, v46, v68 row_newbcast:12 row_mask:0xf bank_mask:0xf
  v_dot2c_f32_bf16_dpp v21, v52, v68 row_newbcast:12 row_mask:0xf bank_mask:0xf
  v_dot2c_f32_bf16_dpp v22, v46, v69 row_newbcast:12 row_mask:0xf bank_mask:0xf
  v_dot2c_f32_bf16_dpp v23, v52, v69 row_newbcast:12 row_mask:0xf bank_mask:0xf
  v_dot2c_f32_bf16_dpp v24, v46, v70 row_newbcast:12 row_mask:0xf bank_mask:0xf
  v_dot2c_f32_bf16_dpp v25, v52, v70 row_newbcast:12 row_mask:0xf bank_mask:0xf
  v_dot2c_f32_bf16_dpp v26, v46, v71 row_newbcast:12 row_mask:0xf bank_mask:0xf
  v_dot2c_f32_bf16_dpp v27, v52, v71 row_newbcast:12 row_mask:0xf bank_mask:0xf
  global_load_dwordx4 v[68:71], v1, s[46:47] offset:3072 nt
  s_add_u32 s46, s46, 4096
  s_addc_u32 s47, s47, 0
  v_lshlrev_b32 v53, 16, v47
  s_waitcnt vmcnt(15)
  v_dot2c_f32_bf16_dpp v20, v47, v72 row_newbcast:0 row_mask:0xf bank_mask:0xf
  v_dot2c_f32_bf16_dpp v21, v53, v72 row_newbcast:0 row_mask:0xf bank_mask:0xf
  v_dot2c_f32_bf16_dpp v22, v47, v73 row_newbcast:0 row_mask:0xf bank_mask:0xf
  v_dot2c_f32_bf16_dpp v23, v53, v73 row_newbcast:0 row_mask:0xf bank_mask:0xf
  v_dot2c_f32_bf16_dpp v24, v47, v74 row_newbcast:0 row_mask:0xf bank_mask:0xf
  v_dot2c_f32_bf16_dpp v25, v53, v74 row_newbcast:0 row_mask:0xf bank_mask:0xf
  v_dot2c_f32_bf16_dpp v26, v47, v75 row_newbcast:0 row_mask:0xf bank_mask:0xf
  v_dot2c_f32_bf16_dpp v27, v53, v75 row_newbcast:0 row_mask:0xf bank_mask:0xf
  global_load_dwordx4 v[72:75], v1, s[46:47] offset:0 nt
  s_waitcnt vmcnt(15)
  v_dot2c_f32_bf16_dpp v20, v47, v76 row_newbcast:8 row_mask:0xf bank_mask:0xf
  v_dot2c_f32_bf16_dpp v21, v53, v76 row_newbcast:8 row_mask:0xf bank_mask:0xf
  v_dot2c_f32_bf16_dpp v22, v47, v77 row_newbcast:8 row_mask:0xf bank_mask:0xf
  v_dot2c_f32_bf16_dpp v23, v53, v77 row_newbcast:8 row_mask:0xf bank_mask:0xf
  v_dot2c_f32_bf16_dpp v24, v47, v78 row_newbcast:8 row_mask:0xf bank_mask:0xf
  v_dot2c_f32_bf16_dpp v25, v53, v78 row_newbcast:8 row_mask:0xf bank_mask:0xf
  v_dot2c_f32_bf16_dpp v26, v47, v79 row_newbcast:8 row_mask:0xf bank_mask:0xf
  v_dot2c_f32_bf16_dpp v27, v53, v79 row_newbcast:8 row_mask:0xf bank_mask:0xf
  global_load_dwordx4 v[76:79], v1, s[46:47] offset:1024 nt
  s_waitcnt vmcnt(15)
  v_dot2c_f32_bf16_dpp v20, v47, v80 row_newbcast:4 row_mask:0xf bank_mask:0xf
  v_dot2c_f32_bf16_dpp v21, v53, v80 row_newbcast:4 row_mask:0xf bank_mask:0xf
  v_dot2c_f32_bf16_dpp v22, v47, v81 row_newbcast:4 row_mask:0xf bank_mask:0xf
  v_dot2c_f32_bf16_dpp v23, v53, v81 row_newbcast:4 row_mask:0xf bank_mask:0xf
  v_dot2c_f32_bf16_dpp v24, v47, v82 row_newbcast:4 row_mask:0xf bank_mask:0xf
  v_dot2c_f32_bf16_dpp v25, v53, v82 row_newbcast:4 row_mask:0xf bank_mask:0xf
  v_dot2c_f32_bf16_dpp v26, v47, v83 row_newbcast:4 row_mask:0xf bank_mask:0xf
  v_dot2c_f32_bf16_dpp v27, v53, v83 row_newbcast:4 row_mask:0xf bank_mask:0xf
  global_load_dwordx4 v[80:83], v1, s[46:47] offset:2048 nt
  s_waitcnt vmcnt(15)
  v_dot2c_f32_bf16_dpp v20, v47, v84 row_newbcast:12 row_mask:0xf bank_mask:0xf
  v_dot2c_f32_bf16_dpp v21, v53, v84 row_newbcast:12 row_mask:0xf bank_mask:0xf
  v_dot2c_f32_bf16_dpp v22, v47, v85 row_newbcast:12 row_mask:0xf bank_mask:0xf
  v_dot2c_f32_bf16_dpp v23, v53, v85 row_newbcast:12 row_mask:0xf bank_mask:0xf
  v_dot2c_f32_bf16_dpp v24, v47, v86 row_newbcast:12 row_mask:0xf bank_mask:0xf
  v_dot2c_f32_bf16_dpp v25, v53, v86 row_newbcast:12 row_mask:0xf bank_mask:0xf
  v_dot2c_f32_bf16_dpp v26, v47, v87 row_newbcast:12 row_mask:0xf bank_mask:0xf
  v_dot2c_f32_bf16_dpp v27, v53, v87 row_newbcast:12 row_mask:0xf bank_mask:0xf
  global_load_dwordx4 v[84:87], v1, s[46:47] offset:3072 nt
  s_add_u32 s46, s46, 4096
  s_addc_u32 s47, s47, 0
  v_lshlrev_b32 v52, 16, v48
  s_waitcnt vmcnt(15)
  v_dot2c_f32_bf16_dpp v20, v48, v88 row_newbcast:0 row_mask:0xf bank_mask:0xf
  v_dot2c_f32_bf16_dpp v21, v52, v88 row_newbcast:0 row_mask:0xf bank_mask:0xf
  v_dot2c_f32_bf16_dpp v22, v48, v89 row_newbcast:0 row_mask:0xf bank_mask:0xf
  v_dot2c_f32_bf16_dpp v23, v52, v89 row_newbcast:0 row_mask:0xf bank_mask:0xf
  v_dot2c_f32_bf16_dpp v24, v48, v90 row_newbcast:0 row_mask:0xf bank_mask:0xf
  v_dot2c_f32_bf16_dpp v25, v52, v90 row_newbcast:0 row_mask:0xf bank_mask:0xf
  v_dot2c_f32_bf16_dpp v26, v48, v91 row_newbcast:0 row_mask:0xf bank_mask:0xf
  v_dot2c_f32_bf16_dpp v27, v52, v91 row_newbcast:0 row_mask:0xf bank_mask:0xf
  global_load_dwordx4 v[88:91], v1, s[54:55] offset:0
  s_waitcnt vmcnt(15)
  v_dot2c_f32_bf16_dpp v20, v48, v92 row_newbcast:8 row_mask:0xf bank_mask:0xf
  v_dot2c_f32_bf16_dpp v21, v52, v92 row_newbcast:8 row_mask:0xf bank_mask:0xf
  v_dot2c_f32_bf16_dpp v22, v48, v93 row_newbcast:8 row_mask:0xf bank_mask:0xf
  v_dot2c_f32_bf16_dpp v23, v52, v93 row_newbcast:8 row_mask:0xf bank_mask:0xf
  v_dot2c_f32_bf16_dpp v24, v48, v94 row_newbcast:8 row_mask:0xf bank_mask:0xf
  v_dot2c_f32_bf16_dpp v25, v52, v94 row_newbcast:8 row_mask:0xf bank_mask:0xf
  v_dot2c_f32_bf16_dpp v26, v48, v95 row_newbcast:8 row_mask:0xf bank_mask:0xf
  v_dot2c_f32_bf16_dpp v27, v52, v95 row_newbcast:8 row_mask:0xf bank_mask:0xf
  global_load_dwordx4 v[92:95], v1, s[54:55] offset:1024
  s_waitcnt vmcnt(15)
  v_dot2c_f32_bf16_dpp v20, v48, v96 row_newbcast:4 row_mask:0xf bank_mask:0xf
  v_dot2c_f32_bf16_dpp v21, v52, v96 row_newbcast:4 row_mask:0xf bank_mask:0xf
  v_dot2c_f32_bf16_dpp v22, v48, v97 row_newbcast:4 row_mask:0xf bank_mask:0xf
  v_dot2c_f32_bf16_dpp v23, v52, v97 row_newbcast:4 row_mask:0xf bank_mask:0xf
  v_dot2c_f32_bf16_dpp v24, v48, v98 row_newbcast:4 row_mask:0xf bank_mask:0xf
  v_dot2c_f32_bf16_dpp v25, v52, v98 row_newbcast:4 row_mask:0xf bank_mask:0xf
  v_dot2c_f32_bf16_dpp v26, v48, v99 row_newbcast:4 row_mask:0xf bank_mask:0xf
  v_dot2c_f32_bf16_dpp v27, v52, v99 row_newbcast:4 row_mask:0xf bank_mask:0xf
  global_load_dwordx4 v[96:99], v1, s[54:55] offset:2048
  s_waitcnt vmcnt(15)
  v_dot2c_f32_bf16_dpp v20, v48, v100 row_newbcast:12 row_mask:0xf bank_mask:0xf
  v_dot2c_f32_bf16_dpp v21, v52, v100 row_newbcast:12 row_mask:0xf bank_mask:0xf
  v_dot2c_f32_bf16_dpp v22, v48, v101 row_newbcast:12 row_mask:0xf bank_mask:0xf
  v_dot2c_f32_bf16_dpp v23, v52, v101 row_newbcast:12 row_mask:0xf bank_mask:0xf
  v_dot2c_f32_bf16_dpp v24, v48, v102 row_newbcast:12 row_mask:0xf bank_mask:0xf
  v_dot2c_f32_bf16_dpp v25, v52, v102 row_newbcast:12 row_mask:0xf bank_mask:0xf
  v_dot2c_f32_bf16_dpp v26, v48, v103 row_newbcast:12 row_mask:0xf bank_mask:0xf
  v_dot2c_f32_bf16_dpp v27, v52, v103 row_newbcast:12 row_mask:0xf bank_mask:0xf
  global_load_dwordx4 v[100:103], v1, s[54:55] offset:3072
  s_add_u32 s54, s54, 4096
  s_addc_u32 s55, s55, 0
  v_lshlrev_b32 v53, 16, v49
  s_waitcnt vmcnt(15)
  v_dot2c_f32_bf16_dpp v20, v49, v104 row_newbcast:0 row_mask:0xf bank_mask:0xf
  v_dot2c_f32_bf16_dpp v21, v53, v104 row_newbcast:0 row_mask:0xf bank_mask:0xf
  v_dot2c_f32_bf16_dpp v22, v49, v105 row_newbcast:0 row_mask:0xf bank_mask:0xf
  v_dot2c_f32_bf16_dpp v23, v53, v105 row_newbcast:0 row_mask:0xf bank_mask:0xf
  v_dot2c_f32_bf16_dpp v24, v49, v106 row_newbcast:0 row_mask:0xf bank_mask:0xf
  v_dot2c_f32_bf16_dpp v25, v53, v106 row_newbcast:0 row_mask:0xf bank_mask:0xf
  v_dot2c_f32_bf16_dpp v26, v49, v107 row_newbcast:0 row_mask:0xf bank_mask:0xf
  v_dot2c_f32_bf16_dpp v27, v53, v107 row_newbcast:0 row_mask:0xf bank_mask:0xf
  global_load_dwordx4 v[104:107], v1, s[54:55] offset:0
  s_waitcnt vmcnt(15)
  v_dot2c_f32_bf16_dpp v20, v49, v108 row_newbcast:8 row_mask:0xf bank_mask:0xf
  v_dot2c_f32_bf16_dpp v21, v53, v108 row_newbcast:8 row_mask:0xf bank_mask:0xf
  v_dot2c_f32_bf16_dpp v22, v49, v109 row_newbcast:8 row_mask:0xf bank_mask:0xf
  v_dot2c_f32_bf16_dpp v23, v53, v109 row_newbcast:8 row_mask:0xf bank_mask:0xf
  v_dot2c_f32_bf16_dpp v24, v49, v110 row_newbcast:8 row_mask:0xf bank_mask:0xf
  v_dot2c_f32_bf16_dpp v25, v53, v110 row_newbcast:8 row_mask:0xf bank_mask:0xf
  v_dot2c_f32_bf16_dpp v26, v49, v111 row_newbcast:8 row_mask:0xf bank_mask:0xf
  v_dot2c_f32_bf16_dpp v27, v53, v111 row_newbcast:8 row_mask:0xf bank_mask:0xf
  global_load_dwordx4 v[108:111], v1, s[54:55] offset:1024
  s_waitcnt vmcnt(15)
  v_dot2c_f32_bf16_dpp v20, v49, v112 row_newbcast:4 row_mask:0xf bank_mask:0xf
  v_dot2c_f32_bf16_dpp v21, v53, v112 row_newbcast:4 row_mask:0xf bank_mask:0xf
  v_dot2c_f32_bf16_dpp v22, v49, v113 row_newbcast:4 row_mask:0xf bank_mask:0xf
  v_dot2c_f32_bf16_dpp v23, v53, v113 row_newbcast:4 row_mask:0xf bank_mask:0xf
  v_dot2c_f32_bf16_dpp v24, v49, v114 row_newbcast:4 row_mask:0xf bank_mask:0xf
  v_dot2c_f32_bf16_dpp v25, v53, v114 row_newbcast:4 row_mask:0xf bank_mask:0xf
  v_dot2c_f32_bf16_dpp v26, v49, v115 row_newbcast:4 row_mask:0xf bank_mask:0xf
  v_dot2c_f32_bf16_dpp v27, v53, v115 row_newbcast:4 row_mask:0xf bank_mask:0xf
  global_load_dwordx4 v[112:115], v1, s[54:55] offset:2048
  s_waitcnt vmcnt(15)
  v_dot2c_f32_bf16_dpp v20, v49, v116 row_newbcast:12 row_mask:0xf bank_mask:0xf
  v_dot2c_f32_bf16_dpp v21, v53, v116 row_newbcast:12 row_mask:0xf bank_mask:0xf
  v_dot2c_f32_bf16_dpp v22, v49, v117 row_newbcast:12 row_mask:0xf bank_mask:0xf
  v_dot2c_f32_bf16_dpp v23, v53, v117 row_newbcast:12 row_mask:0xf bank_mask:0xf
  v_dot2c_f32_bf16_dpp v24, v49, v118 row_newbcast:12 row_mask:0xf bank_mask:0xf
  v_dot2c_f32_bf16_dpp v25, v53, v118 row_newbcast:12 row_mask:0xf bank_mask:0xf
  v_dot2c_f32_bf16_dpp v26, v49, v119 row_newbcast:12 row_mask:0xf bank_mask:0xf
  v_dot2c_f32_bf16_dpp v27, v53, v119 row_newbcast:12 row_mask:0xf bank_mask:0xf
  global_load_dwordx4 v[116:119], v1, s[54:55] offset:3072
  s_add_u32 s54, s54, 4096
  s_addc_u32 s55, s55, 0
  v_lshlrev_b32 v52, 16, v50
  s_waitcnt vmcnt(15)
  v_dot2c_f32_bf16_dpp v20, v50, v56 row_newbcast:0 row_mask:0xf bank_mask:0xf
  v_dot2c_f32_bf16_dpp v21, v52, v56 row_newbcast:0 row_mask:0xf bank_mask:0xf
  v_dot2c_f32_bf16_dpp v22, v50, v57 row_newbcast:0 row_mask:0xf bank_mask:0xf
  v_dot2c_f32_bf16_dpp v23, v52, v57 row_newbcast:0 row_mask:0xf bank_mask:0xf
  v_dot2c_f32_bf16_dpp v24, v50, v58 row_newbcast:0 row_mask:0xf bank_mask:0xf
  v_dot2c_f32_bf16_dpp v25, v52, v58 row_newbcast:0 row_mask:0xf bank_mask:0xf
  v_dot2c_f32_bf16_dpp v26, v50, v59 row_newbcast:0 row_mask:0xf bank_mask:0xf
  v_dot2c_f32_bf16_dpp v27, v52, v59 row_newbcast:0 row_mask:0xf bank_mask:0xf
  s_waitcnt vmcnt(14)
  v_dot2c_f32_bf16_dpp v20, v50, v60 row_newbcast:8 row_mask:0xf bank_mask:0xf
  v_dot2c_f32_bf16_dpp v21, v52, v60 row_newbcast:8 row_mask:0xf bank_mask:0xf
  v_dot2c_f32_bf16_dpp v22, v50, v61 row_newbcast:8 row_mask:0xf bank_mask:0xf
  v_dot2c_f32_bf16_dpp v23, v52, v61 row_newbcast:8 row_mask:0xf bank_mask:0xf
  v_dot2c_f32_bf16_dpp v24, v50, v62 row_newbcast:8 row_mask:0xf bank_mask:0xf
  v_dot2c_f32_bf16_dpp v25, v52, v62 row_newbcast:8 row_mask:0xf bank_mask:0xf
  v_dot2c_f32_bf16_dpp v26, v50, v63 row_newbcast:8 row_mask:0xf bank_mask:0xf
  v_dot2c_f32_bf16_dpp v27, v52, v63 row_newbcast:8 row_mask:0xf bank_mask:0xf
  s_waitcnt vmcnt(13)
  v_dot2c_f32_bf16_dpp v20, v50, v64 row_newbcast:4 row_mask:0xf bank_mask:0xf
  v_dot2c_f32_bf16_dpp v21, v52, v64 row_newbcast:4 row_mask:0xf bank_mask:0xf
  v_dot2c_f32_bf16_dpp v22, v50, v65 row_newbcast:4 row_mask:0xf bank_mask:0xf
  v_dot2c_f32_bf16_dpp v23, v52, v65 row_newbcast:4 row_mask:0xf bank_mask:0xf
  v_dot2c_f32_bf16_dpp v24, v50, v66 row_newbcast:4 row_mask:0xf bank_mask:0xf
  v_dot2c_f32_bf16_dpp v25, v52, v66 row_newbcast:4 row_mask:0xf bank_mask:0xf
  v_dot2c_f32_bf16_dpp v26, v50, v67 row_newbcast:4 row_mask:0xf bank_mask:0xf
  v_dot2c_f32_bf16_dpp v27, v52, v67 row_newbcast:4 row_mask:0xf bank_mask:0xf
  s_waitcnt vmcnt(12)
  v_dot2c_f32_bf16_dpp v20, v50, v68 row_newbcast:12 row_mask:0xf bank_mask:0xf
  v_dot2c_f32_bf16_dpp v21, v52, v68 row_newbcast:12 row_mask:0xf bank_mask:0xf
  v_dot2c_f32_bf16_dpp v22, v50, v69 row_newbcast:12 row_mask:0xf bank_mask:0xf
  v_dot2c_f32_bf16_dpp v23, v52, v69 row_newbcast:12 row_mask:0xf bank_mask:0xf
  v_dot2c_f32_bf16_dpp v24, v50, v70 row_newbcast:12 row_mask:0xf bank_mask:0xf
  v_dot2c_f32_bf16_dpp v25, v52, v70 row_newbcast:12 row_mask:0xf bank_mask:0xf
  v_dot2c_f32_bf16_dpp v26, v50, v71 row_newbcast:12 row_mask:0xf bank_mask:0xf
  v_dot2c_f32_bf16_dpp v27, v52, v71 row_newbcast:12 row_mask:0xf bank_mask:0xf
  v_lshlrev_b32 v53, 16, v51
  s_waitcnt vmcnt(11)
  v_dot2c_f32_bf16_dpp v20, v51, v72 row_newbcast:0 row_mask:0xf bank_mask:0xf
  v_dot2c_f32_bf16_dpp v21, v53, v72 row_newbcast:0 row_mask:0xf bank_mask:0xf
  v_dot2c_f32_bf16_dpp v22, v51, v73 row_newbcast:0 row_mask:0xf bank_mask:0xf
  v_dot2c_f32_bf16_dpp v23, v53, v73 row_newbcast:0 row_mask:0xf bank_mask:0xf
  v_dot2c_f32_bf16_dpp v24, v51, v74 row_newbcast:0 row_mask:0xf bank_mask:0xf
  v_dot2c_f32_bf16_dpp v25, v53, v74 row_newbcast:0 row_mask:0xf bank_mask:0xf
  v_dot2c_f32_bf16_dpp v26, v51, v75 row_newbcast:0 row_mask:0xf bank_mask:0xf
  v_dot2c_f32_bf16_dpp v27, v53, v75 row_newbcast:0 row_mask:0xf bank_mask:0xf
  s_waitcnt vmcnt(10)
  v_dot2c_f32_bf16_dpp v20, v51, v76 row_newbcast:8 row_mask:0xf bank_mask:0xf
  v_dot2c_f32_bf16_dpp v21, v53, v76 row_newbcast:8 row_mask:0xf bank_mask:0xf
  v_dot2c_f32_bf16_dpp v22, v51, v77 row_newbcast:8 row_mask:0xf bank_mask:0xf
  v_dot2c_f32_bf16_dpp v23, v53, v77 row_newbcast:8 row_mask:0xf bank_mask:0xf
  v_dot2c_f32_bf16_dpp v24, v51, v78 row_newbcast:8 row_mask:0xf bank_mask:0xf
  v_dot2c_f32_bf16_dpp v25, v53, v78 row_newbcast:8 row_mask:0xf bank_mask:0xf
  v_dot2c_f32_bf16_dpp v26, v51, v79 row_newbcast:8 row_mask:0xf bank_mask:0xf
  v_dot2c_f32_bf16_dpp v27, v53, v79 row_newbcast:8 row_mask:0xf bank_mask:0xf
  s_waitcnt vmcnt(9)
  v_dot2c_f32_bf16_dpp v20, v51, v80 row_newbcast:4 row_mask:0xf bank_mask:0xf
  v_dot2c_f32_bf16_dpp v21, v53, v80 row_newbcast:4 row_mask:0xf bank_mask:0xf
  v_dot2c_f32_bf16_dpp v22, v51, v81 row_newbcast:4 row_mask:0xf bank_mask:0xf
  v_dot2c_f32_bf16_dpp v23, v53, v81 row_newbcast:4 row_mask:0xf bank_mask:0xf
  v_dot2c_f32_bf16_dpp v24, v51, v82 row_newbcast:4 row_mask:0xf bank_mask:0xf
  v_dot2c_f32_bf16_dpp v25, v53, v82 row_newbcast:4 row_mask:0xf bank_mask:0xf
  v_dot2c_f32_bf16_dpp v26, v51, v83 row_newbcast:4 row_mask:0xf bank_mask:0xf
  v_dot2c_f32_bf16_dpp v27, v53, v83 row_newbcast:4 row_mask:0xf bank_mask:0xf
  s_waitcnt vmcnt(8)
  v_dot2c_f32_bf16_dpp v20, v51, v84 row_newbcast:12 row_mask:0xf bank_mask:0xf
  v_dot2c_f32_bf16_dpp v21, v53, v84 row_newbcast:12 row_mask:0xf bank_mask:0xf
  v_dot2c_f32_bf16_dpp v22, v51, v85 row_newbcast:12 row_mask:0xf bank_mask:0xf
  v_dot2c_f32_bf16_dpp v23, v53, v85 row_newbcast:12 row_mask:0xf bank_mask:0xf
  v_dot2c_f32_bf16_dpp v24, v51, v86 row_newbcast:12 row_mask:0xf bank_mask:0xf
  v_dot2c_f32_bf16_dpp v25, v53, v86 row_newbcast:12 row_mask:0xf bank_mask:0xf
  v_dot2c_f32_bf16_dpp v26, v51, v87 row_newbcast:12 row_mask:0xf bank_mask:0xf
  v_dot2c_f32_bf16_dpp v27, v53, v87 row_newbcast:12 row_mask:0xf bank_mask:0xf
  s_lshl_b32 s7, s6, 11
  v_lshlrev_b32 v14, 9, v3
  v_lshlrev_b32 v13, 5, v2
  v_add_u32 v14, v14, v13
  v_add_u32 v14, s7, v14
  ds_write_b128 v14, v[20:23] offset:0
  ds_write_b128 v14, v[24:27] offset:16
  s_waitcnt lgkmcnt(0)
  s_barrier
  v_and_b32 v13, 127, v0
  v_lshlrev_b32 v13, 2, v13
  v_lshrrev_b32 v14, 7, v0
  v_lshlrev_b32 v12, 12, v14
  v_add_u32 v12, v12, v13
  ds_read_b32 v28, v12 offset:0
  ds_read_b32 v29, v12 offset:512
  ds_read_b32 v30, v12 offset:1024
  ds_read_b32 v31, v12 offset:1536
  ds_read_b32 v32, v12 offset:2048
  ds_read_b32 v33, v12 offset:2560
  ds_read_b32 v34, v12 offset:3072
  ds_read_b32 v35, v12 offset:3584
  s_waitcnt lgkmcnt(6)
  v_add_f32 v8, v28, v29
  s_waitcnt lgkmcnt(5)
  v_add_f32 v8, v8, v30
  s_waitcnt lgkmcnt(4)
  v_add_f32 v8, v8, v31
  s_waitcnt lgkmcnt(3)
  v_add_f32 v8, v8, v32
  s_waitcnt lgkmcnt(2)
  v_add_f32 v8, v8, v33
  s_waitcnt lgkmcnt(1)
  v_add_f32 v8, v8, v34
  s_waitcnt lgkmcnt(0)
  v_add_f32 v8, v8, v35
  v_lshlrev_b32 v12, 9, v14
  v_add_u32 v12, v12, v13
  ds_write_b32 v12, v8 offset:32768
  s_waitcnt lgkmcnt(0)
  s_barrier
  s_cmp_ge_u32 s6, 2
  s_cbranch_scc1 L_red_skip_o
  ds_read_b32 v28, v13 offset:32768
  ds_read_b32 v29, v13 offset:33280
  ds_read_b32 v30, v13 offset:33792
  ds_read_b32 v31, v13 offset:34304
  ds_read_b32 v32, v13 offset:34816
  ds_read_b32 v33, v13 offset:35328
  ds_read_b32 v34, v13 offset:35840
  ds_read_b32 v35, v13 offset:36352
  s_waitcnt lgkmcnt(6)
  v_add_f32 v8, v28, v29
  s_waitcnt lgkmcnt(5)
  v_add_f32 v8, v8, v30
  s_waitcnt lgkmcnt(4)
  v_add_f32 v8, v8, v31
  s_waitcnt lgkmcnt(3)
  v_add_f32 v8, v8, v32
  s_waitcnt lgkmcnt(2)
  v_add_f32 v8, v8, v33
  s_waitcnt lgkmcnt(1)
  v_add_f32 v8, v8, v34
  s_waitcnt lgkmcnt(0)
  v_add_f32 v8, v8, v35
  v_cvt_pk_bf16_f32 v8, v8, 0
  ds_write_b32 v13, v8 offset:37376
  v_lshlrev_b32 v8, 16, v8
  ds_write_b32 v13, v8 offset:37888
L_red_skip_o:
  s_nop 7
  s_waitcnt lgkmcnt(0)
  s_barrier
  s_lshl_b32 s7, s6, 5
  v_mov_b32 v14, s7
  ds_read_b128 v[28:31], v14 offset:37376
  ds_read_b128 v[32:35], v14 offset:37392
  ds_read_b128 v[36:39], v14 offset:37888
  ds_read_b128 v[40:43], v14 offset:37904
  v_mov_b32 v20, 0
  v_mov_b32 v21, 0
  v_mov_b32 v22, 0
  v_mov_b32 v23, 0
  v_mov_b32 v24, 0
  v_mov_b32 v25, 0
  v_mov_b32 v26, 0
  v_mov_b32 v27, 0
  s_waitcnt lgkmcnt(0)
  s_waitcnt vmcnt(7)
  v_dot2c_f32_bf16 v20, v28, v88
  v_dot2c_f32_bf16 v21, v36, v88
  v_dot2c_f32_bf16 v22, v28, v89
  v_dot2c_f32_bf16 v23, v36, v89
  v_dot2c_f32_bf16 v24, v28, v90
  v_dot2c_f32_bf16 v25, v36, v90
  v_dot2c_f32_bf16 v26, v28, v91
  v_dot2c_f32_bf16 v27, v36, v91
  s_waitcnt vmcnt(6)
  v_dot2c_f32_bf16 v20, v29, v92
  v_dot2c_f32_bf16 v21, v37, v92
  v_dot2c_f32_bf16 v22, v29, v93
  v_dot2c_f32_bf16 v23, v37, v93
  v_dot2c_f32_bf16 v24, v29, v94
  v_dot2c_f32_bf16 v25, v37, v94
  v_dot2c_f32_bf16 v26, v29, v95
  v_dot2c_f32_bf16 v27, v37, v95
  s_waitcnt vmcnt(5)
  v_dot2c_f32_bf16 v20, v30, v96
  v_dot2c_f32_bf16 v21, v38, v96
  v_dot2c_f32_bf16 v22, v30, v97
  v_dot2c_f32_bf16 v23, v38, v97
  v_dot2c_f32_bf16 v24, v30, v98
  v_dot2c_f32_bf16 v25, v38, v98
  v_dot2c_f32_bf16 v26, v30, v99
  v_dot2c_f32_bf16 v27, v38, v99
  s_waitcnt vmcnt(4)
  v_dot2c_f32_bf16 v20, v31, v100
  v_dot2c_f32_bf16 v21, v39, v100
  v_dot2c_f32_bf16 v22, v31, v101
  v_dot2c_f32_bf16 v23, v39, v101
  v_dot2c_f32_bf16 v24, v31, v102
  v_dot2c_f32_bf16 v25, v39, v102
  v_dot2c_f32_bf16 v26, v31, v103
  v_dot2c_f32_bf16 v27, v39, v103
  s_waitcnt vmcnt(3)
  v_dot2c_f32_bf16 v20, v32, v104
  v_dot2c_f32_bf16 v21, v40, v104
  v_dot2c_f32_bf16 v22, v32, v105
  v_dot2c_f32_bf16 v23, v40, v105
  v_dot2c_f32_bf16 v24, v32, v106
  v_dot2c_f32_bf16 v25, v40, v106
  v_dot2c_f32_bf16 v26, v32, v107
  v_dot2c_f32_bf16 v27, v40, v107
  s_waitcnt vmcnt(2)
  v_dot2c_f32_bf16 v20, v33, v108
  v_dot2c_f32_bf16 v21, v41, v108
  v_dot2c_f32_bf16 v22, v33, v109
  v_dot2c_f32_bf16 v23, v41, v109
  v_dot2c_f32_bf16 v24, v33, v110
  v_dot2c_f32_bf16 v25, v41, v110
  v_dot2c_f32_bf16 v26, v33, v111
  v_dot2c_f32_bf16 v27, v41, v111
  s_waitcnt vmcnt(1)
  v_dot2c_f32_bf16 v20, v34, v112
  v_dot2c_f32_bf16 v21, v42, v112
  v_dot2c_f32_bf16 v22, v34, v113
  v_dot2c_f32_bf16 v23, v42, v113
  v_dot2c_f32_bf16 v24, v34, v114
  v_dot2c_f32_bf16 v25, v42, v114
  v_dot2c_f32_bf16 v26, v34, v115
  v_dot2c_f32_bf16 v27, v42, v115
  s_waitcnt vmcnt(0)
  v_dot2c_f32_bf16 v20, v35, v116
  v_dot2c_f32_bf16 v21, v43, v116
  v_dot2c_f32_bf16 v22, v35, v117
  v_dot2c_f32_bf16 v23, v43, v117
  v_dot2c_f32_bf16 v24, v35, v118
  v_dot2c_f32_bf16 v25, v43, v118
  v_dot2c_f32_bf16 v26, v35, v119
  v_dot2c_f32_bf16 v27, v43, v119
  s_lshl_b32 s7, s6, 11
  v_lshlrev_b32 v14, 1, v1
  v_add_u32 v14, s7, v14
  ds_write_b128 v14, v[20:23] offset:0
  ds_write_b128 v14, v[24:27] offset:16
  s_waitcnt lgkmcnt(0)
  s_barrier
  s_cmp_ge_u32 s6, 8
  s_cbranch_scc1 L_att_role_end
  v_lshlrev_b32 v14, 2, v0
  ds_read_b32 v28, v14 offset:0
  ds_read_b32 v29, v14 offset:2048
  ds_read_b32 v30, v14 offset:4096
  ds_read_b32 v31, v14 offset:6144
  ds_read_b32 v32, v14 offset:8192
  ds_read_b32 v33, v14 offset:10240
  ds_read_b32 v34, v14 offset:12288
  ds_read_b32 v35, v14 offset:14336
  ds_read_b32 v36, v14 offset:16384
  ds_read_b32 v37, v14 offset:18432
  ds_read_b32 v38, v14 offset:20480
  ds_read_b32 v39, v14 offset:22528
  ds_read_b32 v40, v14 offset:24576
  ds_read_b32 v41, v14 offset:26624
  ds_read_b32 v42, v14 offset:28672
  ds_read_b32 v43, v14 offset:30720
  s_waitcnt lgkmcnt(14)
  v_add_f32 v12, v28, v29
  s_waitcnt lgkmcnt(13)
  v_add_f32 v12, v12, v30
  s_waitcnt lgkmcnt(12)
  v_add_f32 v12, v12, v31
  s_waitcnt lgkmcnt(11)
  v_add_f32 v12, v12, v32
  s_waitcnt lgkmcnt(10)
  v_add_f32 v12, v12, v33
  s_waitcnt lgkmcnt(9)
  v_add_f32 v12, v12, v34
  s_waitcnt lgkmcnt(8)
  v_add_f32 v12, v12, v35
  s_waitcnt lgkmcnt(7)
  v_add_f32 v12, v12, v36
  s_waitcnt lgkmcnt(6)
  v_add_f32 v12, v12, v37
  s_waitcnt lgkmcnt(5)
  v_add_f32 v12, v12, v38
  s_waitcnt lgkmcnt(4)
  v_add_f32 v12, v12, v39
  s_waitcnt lgkmcnt(3)
  v_add_f32 v12, v12, v40
  s_waitcnt lgkmcnt(2)
  v_add_f32 v12, v12, v41
  s_waitcnt lgkmcnt(1)
  v_add_f32 v12, v12, v42
  s_waitcnt lgkmcnt(0)
  v_add_f32 v12, v12, v43
  s_lshl_b32 s7, s4, 11
  s_add_u32 s7, s7, 65536
  s_add_u32 s8, s42, s7
  s_addc_u32 s9, s43, 0
  global_atomic_add_f32 v14, v12, s[8:9]
L_att_role_end:
  s_nop 7
  s_branch L_att_end
L_helper:
  s_nop 7
  s_waitcnt lgkmcnt(0)
  v_bfe_u32 v3, v0, 3, 3
  v_and_b32 v2, 7, v0
  v_mul_u32_u24 v5, 6144, v3
  v_lshlrev_b32 v4, 4, v2
  v_add_u32 v5, v5, v4
  v_lshlrev_b32 v6, 1, v3
  v_mov_b32 v7, 0
  s_add_u32 s3, s2, 0
  s_and_b32 s4, s3, 3
  s_lshr_b32 s5, s3, 2
  s_cmp_lg_u32 s5, 0
  s_cbranch_scc1 L_nozero
  v_cmp_gt_u32 vcc, 512, v0
  s_and_saveexec_b64 s[10:11], vcc
  s_lshl_b32 s7, s4, 11
  s_add_u32 s7, s7, 65536
  s_add_u32 s8, s42, s7
  s_addc_u32 s9, s43, 0
  v_lshlrev_b32 v8, 2, v0
  global_store_dword v8, v7, s[8:9] sc1
  s_add_u32 s8, s8, 8192
  s_addc_u32 s9, s9, 0
  global_store_dword v8, v7, s[8:9] sc1
  s_mov_b64 exec, s[10:11]
L_nozero:
  s_nop 7
  s_lshl_b32 s7, s4, 10
  s_lshl_b32 s8, s6, 6
  s_add_u32 s7, s7, s8
  s_add_u32 s44, s34, s7
  s_addc_u32 s45, s35, 0
  global_load_ushort v8, v6, s[44:45] offset:0
  global_load_ushort v9, v6, s[44:45] offset:16
  global_load_ushort v10, v6, s[44:45] offset:32
  global_load_ushort v11, v6, s[44:45] offset:48
  s_lshl_b32 s7, s5, 7
  s_mul_i32 s8, s6, 196608
  s_add_u32 s7, s7, s8
  s_add_u32 s46, s36, s7
  s_addc_u32 s47, s37, 0
  global_load_dwordx4 v[32:35], v5, s[46:47]
  s_add_u32 s46, s46, 49152
  s_addc_u32 s47, s47, 0
  global_load_dwordx4 v[36:39], v5, s[46:47]
  s_add_u32 s46, s46, 49152
  s_addc_u32 s47, s47, 0
  global_load_dwordx4 v[40:43], v5, s[46:47]
  s_add_u32 s46, s46, 49152
  s_addc_u32 s47, s47, 0
  global_load_dwordx4 v[44:47], v5, s[46:47]
  s_waitcnt vmcnt(7)
  v_lshlrev_b32 v8, 16, v8
  v_mul_f32 v20, s50, v8
  v_sub_f32 v20, 0, v20
  v_exp_f32 v20, v20
  s_nop 0
  v_add_f32 v20, 1.0, v20
  v_rcp_f32 v21, v20
  s_nop 0
  v_mul_f32 v22, v8, v21
  v_fma_f32 v23, -v22, v20, v8
  v_fma_f32 v20, v23, v21, v22
  v_cvt_pk_bf16_f32 v12, v20, 0
  v_lshlrev_b32 v16, 16, v12
  s_waitcnt vmcnt(6)
  v_lshlrev_b32 v9, 16, v9
  v_mul_f32 v20, s50, v9
  v_sub_f32 v20, 0, v20
  v_exp_f32 v20, v20
  s_nop 0
  v_add_f32 v20, 1.0, v20
  v_rcp_f32 v21, v20
  s_nop 0
  v_mul_f32 v22, v9, v21
  v_fma_f32 v23, -v22, v20, v9
  v_fma_f32 v20, v23, v21, v22
  v_cvt_pk_bf16_f32 v13, v20, 0
  v_lshlrev_b32 v17, 16, v13
  s_waitcnt vmcnt(5)
  v_lshlrev_b32 v10, 16, v10
  v_mul_f32 v20, s50, v10
  v_sub_f32 v20, 0, v20
  v_exp_f32 v20, v20
  s_nop 0
  v_add_f32 v20, 1.0, v20
  v_rcp_f32 v21, v20
  s_nop 0
  v_mul_f32 v22, v10, v21
  v_fma_f32 v23, -v22, v20, v10
  v_fma_f32 v20, v23, v21, v22
  v_cvt_pk_bf16_f32 v14, v20, 0
  v_lshlrev_b32 v18, 16, v14
  s_waitcnt vmcnt(4)
  v_lshlrev_b32 v11, 16, v11
  v_mul_f32 v20, s50, v11
  v_sub_f32 v20, 0, v20
  v_exp_f32 v20, v20
  s_nop 0
  v_add_f32 v20, 1.0, v20
  v_rcp_f32 v21, v20
  s_nop 0
  v_mul_f32 v22, v11, v21
  v_fma_f32 v23, -v22, v20, v11
  v_fma_f32 v20, v23, v21, v22
  v_cvt_pk_bf16_f32 v15, v20, 0
  v_lshlrev_b32 v19, 16, v15
  v_mov_b32 v20, 0
  v_mov_b32 v21, 0
  v_mov_b32 v22, 0
  v_mov_b32 v23, 0
  v_mov_b32 v24, 0
  v_mov_b32 v25, 0
  v_mov_b32 v26, 0
  v_mov_b32 v27, 0
  s_waitcnt vmcnt(3)
  v_dot2c_f32_bf16 v20, v12, v32
  v_dot2c_f32_bf16 v21, v16, v32
  v_dot2c_f32_bf16 v22, v12, v33
  v_dot2c_f32_bf16 v23, v16, v33
  v_dot2c_f32_bf16 v24, v12, v34
  v_dot2c_f32_bf16 v25, v16, v34
  v_dot2c_f32_bf16 v26, v12, v35
  v_dot2c_f32_bf16 v27, v16, v35
  s_waitcnt vmcnt(2)
  v_dot2c_f32_bf16 v20, v13, v36
  v_dot2c_f32_bf16 v21, v17, v36
  v_dot2c_f32_bf16 v22, v13, v37
  v_dot2c_f32_bf16 v23, v17, v37
  v_dot2c_f32_bf16 v24, v13, v38
  v_dot2c_f32_bf16 v25, v17, v38
  v_dot2c_f32_bf16 v26, v13, v39
  v_dot2c_f32_bf16 v27, v17, v39
  s_waitcnt vmcnt(1)
  v_dot2c_f32_bf16 v20, v14, v40
  v_dot2c_f32_bf16 v21, v18, v40
  v_dot2c_f32_bf16 v22, v14, v41
  v_dot2c_f32_bf16 v23, v18, v41
  v_dot2c_f32_bf16 v24, v14, v42
  v_dot2c_f32_bf16 v25, v18, v42
  v_dot2c_f32_bf16 v26, v14, v43
  v_dot2c_f32_bf16 v27, v18, v43
  s_waitcnt vmcnt(0)
  v_dot2c_f32_bf16 v20, v15, v44
  v_dot2c_f32_bf16 v21, v19, v44
  v_dot2c_f32_bf16 v22, v15, v45
  v_dot2c_f32_bf16 v23, v19, v45
  v_dot2c_f32_bf16 v24, v15, v46
  v_dot2c_f32_bf16 v25, v19, v46
  v_dot2c_f32_bf16 v26, v15, v47
  v_dot2c_f32_bf16 v27, v19, v47
  s_lshl_b32 s7, s6, 11
  v_lshlrev_b32 v28, 8, v3
  v_lshlrev_b32 v29, 5, v2
  v_add_u32 v28, v28, v29
  v_add_u32 v28, s7, v28
  ds_write_b128 v28, v[20:23] offset:0
  ds_write_b128 v28, v[24:27] offset:16
  s_waitcnt vmcnt(0)
  s_waitcnt lgkmcnt(0)
  s_barrier
  v_and_b32 v28, 63, v0
  v_lshlrev_b32 v28, 2, v28
  s_lshl_b32 s7, s6, 11
  v_add_u32 v29, s7, v28
  ds_read_b32 v32, v29 offset:0
  ds_read_b32 v33, v29 offset:256
  ds_read_b32 v34, v29 offset:512
  ds_read_b32 v35, v29 offset:768
  ds_read_b32 v36, v29 offset:1024
  ds_read_b32 v37, v29 offset:1280
  ds_read_b32 v38, v29 offset:1536
  ds_read_b32 v39, v29 offset:1792
  s_waitcnt lgkmcnt(6)
  v_add_f32 v30, v32, v33
  s_waitcnt lgkmcnt(5)
  v_add_f32 v30, v30, v34
  s_waitcnt lgkmcnt(4)
  v_add_f32 v30, v30, v35
  s_waitcnt lgkmcnt(3)
  v_add_f32 v30, v30, v36
  s_waitcnt lgkmcnt(2)
  v_add_f32 v30, v30, v37
  s_waitcnt lgkmcnt(1)
  v_add_f32 v30, v30, v38
  s_waitcnt lgkmcnt(0)
  v_add_f32 v30, v30, v39
  s_lshl_b32 s7, s6, 8
  v_add_u32 v29, s7, v28
  ds_write_b32 v29, v30 offset:32768
  s_waitcnt lgkmcnt(0)
  s_barrier
  s_cmp_lg_u32 s6, 0
  s_cbranch_scc1 L_h2skip0
  ds_read_b32 v32, v28 offset:32768
  ds_read_b32 v33, v28 offset:33024
  ds_read_b32 v34, v28 offset:33280
  ds_read_b32 v35, v28 offset:33536
  ds_read_b32 v36, v28 offset:33792
  ds_read_b32 v37, v28 offset:34048
  ds_read_b32 v38, v28 offset:34304
  ds_read_b32 v39, v28 offset:34560
  ds_read_b32 v40, v28 offset:34816
  ds_read_b32 v41, v28 offset:35072
  ds_read_b32 v42, v28 offset:35328
  ds_read_b32 v43, v28 offset:35584
  ds_read_b32 v44, v28 offset:35840
  ds_read_b32 v45, v28 offset:36096
  ds_read_b32 v46, v28 offset:36352
  ds_read_b32 v47, v28 offset:36608
  s_waitcnt lgkmcnt(14)
  v_add_f32 v30, v32, v33
  s_waitcnt lgkmcnt(13)
  v_add_f32 v30, v30, v34
  s_waitcnt lgkmcnt(12)
  v_add_f32 v30, v30, v35
  s_waitcnt lgkmcnt(11)
  v_add_f32 v30, v30, v36
  s_waitcnt lgkmcnt(10)
  v_add_f32 v30, v30, v37
  s_waitcnt lgkmcnt(9)
  v_add_f32 v30, v30, v38
  s_waitcnt lgkmcnt(8)
  v_add_f32 v30, v30, v39
  s_waitcnt lgkmcnt(7)
  v_add_f32 v30, v30, v40
  s_waitcnt lgkmcnt(6)
  v_add_f32 v30, v30, v41
  s_waitcnt lgkmcnt(5)
  v_add_f32 v30, v30, v42
  s_waitcnt lgkmcnt(4)
  v_add_f32 v30, v30, v43
  s_waitcnt lgkmcnt(3)
  v_add_f32 v30, v30, v44
  s_waitcnt lgkmcnt(2)
  v_add_f32 v30, v30, v45
  s_waitcnt lgkmcnt(1)
  v_add_f32 v30, v30, v46
  s_waitcnt lgkmcnt(0)
  v_add_f32 v30, v30, v47
  v_cvt_pk_bf16_f32 v30, v30, v30
  v_lshlrev_b32 v30, 16, v30
  s_mul_i32 s7, s4, 12288
  s_lshl_b32 s8, s5, 8
  s_add_u32 s7, s7, s8
  s_add_u32 s8, s42, s7
  s_addc_u32 s9, s43, 0
  global_store_dword v28, v30, s[8:9] offset:0 sc1
  s_waitcnt vmcnt(0)
  s_lshl_b32 s7, s4, 2
  v_mov_b32 v31, s7
  v_mov_b32 v30, 1
  s_mov_b64 exec, 1
  global_atomic_add v31, v30, s[40:41] sc1
  s_mov_b64 exec, -1
L_h2skip0:
  s_nop 7
  s_barrier
  s_add_u32 s3, s2, 64
  s_and_b32 s4, s3, 3
  s_lshr_b32 s5, s3, 2
  s_lshl_b32 s7, s4, 10
  s_lshl_b32 s8, s6, 6
  s_add_u32 s7, s7, s8
  s_add_u32 s44, s34, s7
  s_addc_u32 s45, s35, 0
  global_load_ushort v8, v6, s[44:45] offset:0
  global_load_ushort v9, v6, s[44:45] offset:16
  global_load_ushort v10, v6, s[44:45] offset:32
  global_load_ushort v11, v6, s[44:45] offset:48
  s_lshl_b32 s7, s5, 7
  s_mul_i32 s8, s6, 196608
  s_add_u32 s7, s7, s8
  s_add_u32 s46, s36, s7
  s_addc_u32 s47, s37, 0
  global_load_dwordx4 v[32:35], v5, s[46:47]
  s_add_u32 s46, s46, 49152
  s_addc_u32 s47, s47, 0
  global_load_dwordx4 v[36:39], v5, s[46:47]
  s_add_u32 s46, s46, 49152
  s_addc_u32 s47, s47, 0
  global_load_dwordx4 v[40:43], v5, s[46:47]
  s_add_u32 s46, s46, 49152
  s_addc_u32 s47, s47, 0
  global_load_dwordx4 v[44:47], v5, s[46:47]
  s_waitcnt vmcnt(7)
  v_lshlrev_b32 v8, 16, v8
  v_mul_f32 v20, s50, v8
  v_sub_f32 v20, 0, v20
  v_exp_f32 v20, v20
  s_nop 0
  v_add_f32 v20, 1.0, v20
  v_rcp_f32 v21, v20
  s_nop 0
  v_mul_f32 v22, v8, v21
  v_fma_f32 v23, -v22, v20, v8
  v_fma_f32 v20, v23, v21, v22
  v_cvt_pk_bf16_f32 v12, v20, 0
  v_lshlrev_b32 v16, 16, v12
  s_waitcnt vmcnt(6)
  v_lshlrev_b32 v9, 16, v9
  v_mul_f32 v20, s50, v9
  v_sub_f32 v20, 0, v20
  v_exp_f32 v20, v20
  s_nop 0
  v_add_f32 v20, 1.0, v20
  v_rcp_f32 v21, v20
  s_nop 0
  v_mul_f32 v22, v9, v21
  v_fma_f32 v23, -v22, v20, v9
  v_fma_f32 v20, v23, v21, v22
  v_cvt_pk_bf16_f32 v13, v20, 0
  v_lshlrev_b32 v17, 16, v13
  s_waitcnt vmcnt(5)
  v_lshlrev_b32 v10, 16, v10
  v_mul_f32 v20, s50, v10
  v_sub_f32 v20, 0, v20
  v_exp_f32 v20, v20
  s_nop 0
  v_add_f32 v20, 1.0, v20
  v_rcp_f32 v21, v20
  s_nop 0
  v_mul_f32 v22, v10, v21
  v_fma_f32 v23, -v22, v20, v10
  v_fma_f32 v20, v23, v21, v22
  v_cvt_pk_bf16_f32 v14, v20, 0
  v_lshlrev_b32 v18, 16, v14
  s_waitcnt vmcnt(4)
  v_lshlrev_b32 v11, 16, v11
  v_mul_f32 v20, s50, v11
  v_sub_f32 v20, 0, v20
  v_exp_f32 v20, v20
  s_nop 0
  v_add_f32 v20, 1.0, v20
  v_rcp_f32 v21, v20
  s_nop 0
  v_mul_f32 v22, v11, v21
  v_fma_f32 v23, -v22, v20, v11
  v_fma_f32 v20, v23, v21, v22
  v_cvt_pk_bf16_f32 v15, v20, 0
  v_lshlrev_b32 v19, 16, v15
  v_mov_b32 v20, 0
  v_mov_b32 v21, 0
  v_mov_b32 v22, 0
  v_mov_b32 v23, 0
  v_mov_b32 v24, 0
  v_mov_b32 v25, 0
  v_mov_b32 v26, 0
  v_mov_b32 v27, 0
  s_waitcnt vmcnt(3)
  v_dot2c_f32_bf16 v20, v12, v32
  v_dot2c_f32_bf16 v21, v16, v32
  v_dot2c_f32_bf16 v22, v12, v33
  v_dot2c_f32_bf16 v23, v16, v33
  v_dot2c_f32_bf16 v24, v12, v34
  v_dot2c_f32_bf16 v25, v16, v34
  v_dot2c_f32_bf16 v26, v12, v35
  v_dot2c_f32_bf16 v27, v16, v35
  s_waitcnt vmcnt(2)
  v_dot2c_f32_bf16 v20, v13, v36
  v_dot2c_f32_bf16 v21, v17, v36
  v_dot2c_f32_bf16 v22, v13, v37
  v_dot2c_f32_bf16 v23, v17, v37
  v_dot2c_f32_bf16 v24, v13, v38
  v_dot2c_f32_bf16 v25, v17, v38
  v_dot2c_f32_bf16 v26, v13, v39
  v_dot2c_f32_bf16 v27, v17, v39
  s_waitcnt vmcnt(1)
  v_dot2c_f32_bf16 v20, v14, v40
  v_dot2c_f32_bf16 v21, v18, v40
  v_dot2c_f32_bf16 v22, v14, v41
  v_dot2c_f32_bf16 v23, v18, v41
  v_dot2c_f32_bf16 v24, v14, v42
  v_dot2c_f32_bf16 v25, v18, v42
  v_dot2c_f32_bf16 v26, v14, v43
  v_dot2c_f32_bf16 v27, v18, v43
  s_waitcnt vmcnt(0)
  v_dot2c_f32_bf16 v20, v15, v44
  v_dot2c_f32_bf16 v21, v19, v44
  v_dot2c_f32_bf16 v22, v15, v45
  v_dot2c_f32_bf16 v23, v19, v45
  v_dot2c_f32_bf16 v24, v15, v46
  v_dot2c_f32_bf16 v25, v19, v46
  v_dot2c_f32_bf16 v26, v15, v47
  v_dot2c_f32_bf16 v27, v19, v47
  s_lshl_b32 s7, s6, 11
  v_lshlrev_b32 v28, 8, v3
  v_lshlrev_b32 v29, 5, v2
  v_add_u32 v28, v28, v29
  v_add_u32 v28, s7, v28
  ds_write_b128 v28, v[20:23] offset:0
  ds_write_b128 v28, v[24:27] offset:16
  s_waitcnt vmcnt(0)
  s_waitcnt lgkmcnt(0)
  s_barrier
  v_and_b32 v28, 63, v0
  v_lshlrev_b32 v28, 2, v28
  s_lshl_b32 s7, s6, 11
  v_add_u32 v29, s7, v28
  ds_read_b32 v32, v29 offset:0
  ds_read_b32 v33, v29 offset:256
  ds_read_b32 v34, v29 offset:512
  ds_read_b32 v35, v29 offset:768
  ds_read_b32 v36, v29 offset:1024
  ds_read_b32 v37, v29 offset:1280
  ds_read_b32 v38, v29 offset:1536
  ds_read_b32 v39, v29 offset:1792
  s_waitcnt lgkmcnt(6)
  v_add_f32 v30, v32, v33
  s_waitcnt lgkmcnt(5)
  v_add_f32 v30, v30, v34
  s_waitcnt lgkmcnt(4)
  v_add_f32 v30, v30, v35
  s_waitcnt lgkmcnt(3)
  v_add_f32 v30, v30, v36
  s_waitcnt lgkmcnt(2)
  v_add_f32 v30, v30, v37
  s_waitcnt lgkmcnt(1)
  v_add_f32 v30, v30, v38
  s_waitcnt lgkmcnt(0)
  v_add_f32 v30, v30, v39
  s_lshl_b32 s7, s6, 8
  v_add_u32 v29, s7, v28
  ds_write_b32 v29, v30 offset:32768
  s_waitcnt lgkmcnt(0)
  s_barrier
  s_cmp_lg_u32 s6, 0
  s_cbranch_scc1 L_h2skip1
  ds_read_b32 v32, v28 offset:32768
  ds_read_b32 v33, v28 offset:33024
  ds_read_b32 v34, v28 offset:33280
  ds_read_b32 v35, v28 offset:33536
  ds_read_b32 v36, v28 offset:33792
  ds_read_b32 v37, v28 offset:34048
  ds_read_b32 v38, v28 offset:34304
  ds_read_b32 v39, v28 offset:34560
  ds_read_b32 v40, v28 offset:34816
  ds_read_b32 v41, v28 offset:35072
  ds_read_b32 v42, v28 offset:35328
  ds_read_b32 v43, v28 offset:35584
  ds_read_b32 v44, v28 offset:35840
  ds_read_b32 v45, v28 offset:36096
  ds_read_b32 v46, v28 offset:36352
  ds_read_b32 v47, v28 offset:36608
  s_waitcnt lgkmcnt(14)
  v_add_f32 v30, v32, v33
  s_waitcnt lgkmcnt(13)
  v_add_f32 v30, v30, v34
  s_waitcnt lgkmcnt(12)
  v_add_f32 v30, v30, v35
  s_waitcnt lgkmcnt(11)
  v_add_f32 v30, v30, v36
  s_waitcnt lgkmcnt(10)
  v_add_f32 v30, v30, v37
  s_waitcnt lgkmcnt(9)
  v_add_f32 v30, v30, v38
  s_waitcnt lgkmcnt(8)
  v_add_f32 v30, v30, v39
  s_waitcnt lgkmcnt(7)
  v_add_f32 v30, v30, v40
  s_waitcnt lgkmcnt(6)
  v_add_f32 v30, v30, v41
  s_waitcnt lgkmcnt(5)
  v_add_f32 v30, v30, v42
  s_waitcnt lgkmcnt(4)
  v_add_f32 v30, v30, v43
  s_waitcnt lgkmcnt(3)
  v_add_f32 v30, v30, v44
  s_waitcnt lgkmcnt(2)
  v_add_f32 v30, v30, v45
  s_waitcnt lgkmcnt(1)
  v_add_f32 v30, v30, v46
  s_waitcnt lgkmcnt(0)
  v_add_f32 v30, v30, v47
  v_cvt_pk_bf16_f32 v30, v30, v30
  v_lshlrev_b32 v30, 16, v30
  s_mul_i32 s7, s4, 12288
  s_lshl_b32 s8, s5, 8
  s_add_u32 s7, s7, s8
  s_add_u32 s8, s42, s7
  s_addc_u32 s9, s43, 0
  global_store_dword v28, v30, s[8:9] offset:0 sc1
  s_waitcnt vmcnt(0)
L_h2skip1:
  s_nop 7
  s_barrier
  s_add_u32 s3, s2, 128
  s_and_b32 s4, s3, 3
  s_lshr_b32 s5, s3, 2
  s_lshl_b32 s7, s4, 10
  s_lshl_b32 s8, s6, 6
  s_add_u32 s7, s7, s8
  s_add_u32 s44, s34, s7
  s_addc_u32 s45, s35, 0
  global_load_ushort v8, v6, s[44:45] offset:0
  global_load_ushort v9, v6, s[44:45] offset:16
  global_load_ushort v10, v6, s[44:45] offset:32
  global_load_ushort v11, v6, s[44:45] offset:48
  s_lshl_b32 s7, s5, 7
  s_mul_i32 s8, s6, 196608
  s_add_u32 s7, s7, s8
  s_add_u32 s46, s36, s7
  s_addc_u32 s47, s37, 0
  global_load_dwordx4 v[32:35], v5, s[46:47]
  s_add_u32 s46, s46, 49152
  s_addc_u32 s47, s47, 0
  global_load_dwordx4 v[36:39], v5, s[46:47]
  s_add_u32 s46, s46, 49152
  s_addc_u32 s47, s47, 0
  global_load_dwordx4 v[40:43], v5, s[46:47]
  s_add_u32 s46, s46, 49152
  s_addc_u32 s47, s47, 0
  global_load_dwordx4 v[44:47], v5, s[46:47]
  s_waitcnt vmcnt(7)
  v_lshlrev_b32 v8, 16, v8
  v_mul_f32 v20, s50, v8
  v_sub_f32 v20, 0, v20
  v_exp_f32 v20, v20
  s_nop 0
  v_add_f32 v20, 1.0, v20
  v_rcp_f32 v21, v20
  s_nop 0
  v_mul_f32 v22, v8, v21
  v_fma_f32 v23, -v22, v20, v8
  v_fma_f32 v20, v23, v21, v22
  v_cvt_pk_bf16_f32 v12, v20, 0
  v_lshlrev_b32 v16, 16, v12
  s_waitcnt vmcnt(6)
  v_lshlrev_b32 v9, 16, v9
  v_mul_f32 v20, s50, v9
  v_sub_f32 v20, 0, v20
  v_exp_f32 v20, v20
  s_nop 0
  v_add_f32 v20, 1.0, v20
  v_rcp_f32 v21, v20
  s_nop 0
  v_mul_f32 v22, v9, v21
  v_fma_f32 v23, -v22, v20, v9
  v_fma_f32 v20, v23, v21, v22
  v_cvt_pk_bf16_f32 v13, v20, 0
  v_lshlrev_b32 v17, 16, v13
  s_waitcnt vmcnt(5)
  v_lshlrev_b32 v10, 16, v10
  v_mul_f32 v20, s50, v10
  v_sub_f32 v20, 0, v20
  v_exp_f32 v20, v20
  s_nop 0
  v_add_f32 v20, 1.0, v20
  v_rcp_f32 v21, v20
  s_nop 0
  v_mul_f32 v22, v10, v21
  v_fma_f32 v23, -v22, v20, v10
  v_fma_f32 v20, v23, v21, v22
  v_cvt_pk_bf16_f32 v14, v20, 0
  v_lshlrev_b32 v18, 16, v14
  s_waitcnt vmcnt(4)
  v_lshlrev_b32 v11, 16, v11
  v_mul_f32 v20, s50, v11
  v_sub_f32 v20, 0, v20
  v_exp_f32 v20, v20
  s_nop 0
  v_add_f32 v20, 1.0, v20
  v_rcp_f32 v21, v20
  s_nop 0
  v_mul_f32 v22, v11, v21
  v_fma_f32 v23, -v22, v20, v11
  v_fma_f32 v20, v23, v21, v22
  v_cvt_pk_bf16_f32 v15, v20, 0
  v_lshlrev_b32 v19, 16, v15
  v_mov_b32 v20, 0
  v_mov_b32 v21, 0
  v_mov_b32 v22, 0
  v_mov_b32 v23, 0
  v_mov_b32 v24, 0
  v_mov_b32 v25, 0
  v_mov_b32 v26, 0
  v_mov_b32 v27, 0
  s_waitcnt vmcnt(3)
  v_dot2c_f32_bf16 v20, v12, v32
  v_dot2c_f32_bf16 v21, v16, v32
  v_dot2c_f32_bf16 v22, v12, v33
  v_dot2c_f32_bf16 v23, v16, v33
  v_dot2c_f32_bf16 v24, v12, v34
  v_dot2c_f32_bf16 v25, v16, v34
  v_dot2c_f32_bf16 v26, v12, v35
  v_dot2c_f32_bf16 v27, v16, v35
  s_waitcnt vmcnt(2)
  v_dot2c_f32_bf16 v20, v13, v36
  v_dot2c_f32_bf16 v21, v17, v36
  v_dot2c_f32_bf16 v22, v13, v37
  v_dot2c_f32_bf16 v23, v17, v37
  v_dot2c_f32_bf16 v24, v13, v38
  v_dot2c_f32_bf16 v25, v17, v38
  v_dot2c_f32_bf16 v26, v13, v39
  v_dot2c_f32_bf16 v27, v17, v39
  s_waitcnt vmcnt(1)
  v_dot2c_f32_bf16 v20, v14, v40
  v_dot2c_f32_bf16 v21, v18, v40
  v_dot2c_f32_bf16 v22, v14, v41
  v_dot2c_f32_bf16 v23, v18, v41
  v_dot2c_f32_bf16 v24, v14, v42
  v_dot2c_f32_bf16 v25, v18, v42
  v_dot2c_f32_bf16 v26, v14, v43
  v_dot2c_f32_bf16 v27, v18, v43
  s_waitcnt vmcnt(0)
  v_dot2c_f32_bf16 v20, v15, v44
  v_dot2c_f32_bf16 v21, v19, v44
  v_dot2c_f32_bf16 v22, v15, v45
  v_dot2c_f32_bf16 v23, v19, v45
  v_dot2c_f32_bf16 v24, v15, v46
  v_dot2c_f32_bf16 v25, v19, v46
  v_dot2c_f32_bf16 v26, v15, v47
  v_dot2c_f32_bf16 v27, v19, v47
  s_lshl_b32 s7, s6, 11
  v_lshlrev_b32 v28, 8, v3
  v_lshlrev_b32 v29, 5, v2
  v_add_u32 v28, v28, v29
  v_add_u32 v28, s7, v28
  ds_write_b128 v28, v[20:23] offset:0
  ds_write_b128 v28, v[24:27] offset:16
  s_waitcnt vmcnt(0)
  s_waitcnt lgkmcnt(0)
  s_barrier
  v_and_b32 v28, 63, v0
  v_lshlrev_b32 v28, 2, v28
  s_lshl_b32 s7, s6, 11
  v_add_u32 v29, s7, v28
  ds_read_b32 v32, v29 offset:0
  ds_read_b32 v33, v29 offset:256
  ds_read_b32 v34, v29 offset:512
  ds_read_b32 v35, v29 offset:768
  ds_read_b32 v36, v29 offset:1024
  ds_read_b32 v37, v29 offset:1280
  ds_read_b32 v38, v29 offset:1536
  ds_read_b32 v39, v29 offset:1792
  s_waitcnt lgkmcnt(6)
  v_add_f32 v30, v32, v33
  s_waitcnt lgkmcnt(5)
  v_add_f32 v30, v30, v34
  s_waitcnt lgkmcnt(4)
  v_add_f32 v30, v30, v35
  s_waitcnt lgkmcnt(3)
  v_add_f32 v30, v30, v36
  s_waitcnt lgkmcnt(2)
  v_add_f32 v30, v30, v37
  s_waitcnt lgkmcnt(1)
  v_add_f32 v30, v30, v38
  s_waitcnt lgkmcnt(0)
  v_add_f32 v30, v30, v39
  s_lshl_b32 s7, s6, 8
  v_add_u32 v29, s7, v28
  ds_write_b32 v29, v30 offset:32768
  s_waitcnt lgkmcnt(0)
  s_barrier
  s_cmp_lg_u32 s6, 0
  s_cbranch_scc1 L_h2skip2
  ds_read_b32 v32, v28 offset:32768
  ds_read_b32 v33, v28 offset:33024
  ds_read_b32 v34, v28 offset:33280
  ds_read_b32 v35, v28 offset:33536
  ds_read_b32 v36, v28 offset:33792
  ds_read_b32 v37, v28 offset:34048
  ds_read_b32 v38, v28 offset:34304
  ds_read_b32 v39, v28 offset:34560
  ds_read_b32 v40, v28 offset:34816
  ds_read_b32 v41, v28 offset:35072
  ds_read_b32 v42, v28 offset:35328
  ds_read_b32 v43, v28 offset:35584
  ds_read_b32 v44, v28 offset:35840
  ds_read_b32 v45, v28 offset:36096
  ds_read_b32 v46, v28 offset:36352
  ds_read_b32 v47, v28 offset:36608
  s_waitcnt lgkmcnt(14)
  v_add_f32 v30, v32, v33
  s_waitcnt lgkmcnt(13)
  v_add_f32 v30, v30, v34
  s_waitcnt lgkmcnt(12)
  v_add_f32 v30, v30, v35
  s_waitcnt lgkmcnt(11)
  v_add_f32 v30, v30, v36
  s_waitcnt lgkmcnt(10)
  v_add_f32 v30, v30, v37
  s_waitcnt lgkmcnt(9)
  v_add_f32 v30, v30, v38
  s_waitcnt lgkmcnt(8)
  v_add_f32 v30, v30, v39
  s_waitcnt lgkmcnt(7)
  v_add_f32 v30, v30, v40
  s_waitcnt lgkmcnt(6)
  v_add_f32 v30, v30, v41
  s_waitcnt lgkmcnt(5)
  v_add_f32 v30, v30, v42
  s_waitcnt lgkmcnt(4)
  v_add_f32 v30, v30, v43
  s_waitcnt lgkmcnt(3)
  v_add_f32 v30, v30, v44
  s_waitcnt lgkmcnt(2)
  v_add_f32 v30, v30, v45
  s_waitcnt lgkmcnt(1)
  v_add_f32 v30, v30, v46
  s_waitcnt lgkmcnt(0)
  v_add_f32 v30, v30, v47
  v_cvt_pk_bf16_f32 v30, v30, v30
  v_lshlrev_b32 v30, 16, v30
  s_mul_i32 s7, s4, 12288
  s_lshl_b32 s8, s5, 8
  s_add_u32 s7, s7, s8
  s_add_u32 s8, s42, s7
  s_addc_u32 s9, s43, 0
  global_store_dword v28, v30, s[8:9] offset:0 sc1
  s_waitcnt vmcnt(0)
L_h2skip2:
  s_nop 7
  s_barrier
  s_branch L_att_end
L_att_end:
  s_nop 7
  s_endpgm
.globl adaln_ffn_kernel
.p2align 8
.type adaln_ffn_kernel,@function
adaln_ffn_kernel:
  s_cmp_ge_u32 s2, 56
  s_cbranch_scc1 L_ffn_end
  s_load_dwordx16 s[16:31], s[0:1], 0
  s_load_dwordx8 s[32:39], s[0:1], 64
  s_load_dwordx4 s[40:43], s[0:1], 96
  v_lshrrev_b32 v4, 6, v0
  v_and_b32 v1, 63, v0
  v_readfirstlane_b32 s6, v4
  v_lshlrev_b32 v2, 4, v1
  s_mov_b32 s50, 0x3fb8aa3b
  s_mov_b32 s52, 0x3727c5ac
  s_waitcnt lgkmcnt(0)
  v_lshrrev_b32 v3, 2, v1
  v_mul_u32_u24 v5, 3584, v3
  v_and_b32 v6, 3, v1
  v_lshlrev_b32 v6, 4, v6
  v_add_u32 v5, v5, v6
  s_mul_i32 s7, s6, 114688
  s_lshl_b32 s8, s2, 6
  s_add_u32 s7, s7, s8
  s_add_u32 s44, s28, s7
  s_addc_u32 s45, s29, 0
  s_add_u32 s46, s30, s7
  s_addc_u32 s47, s31, 0
  global_load_dwordx4 v[64:67], v5, s[44:45]
  global_load_dwordx4 v[72:75], v5, s[46:47]
  s_add_u32 s44, s44, 57344
  s_addc_u32 s45, s45, 0
  s_add_u32 s46, s46, 57344
  s_addc_u32 s47, s47, 0
  global_load_dwordx4 v[68:71], v5, s[44:45]
  global_load_dwordx4 v[76:79], v5, s[46:47]
  s_lshl_b32 s7, s2, 15
  s_lshl_b32 s8, s6, 11
  s_add_u32 s7, s7, s8
  s_add_u32 s48, s32, s7
  s_addc_u32 s49, s33, 0
  global_load_dwordx4 v[80:83], v2, s[48:49]
  global_load_dwordx4 v[84:87], v2, s[48:49] offset:1024
  s_cmp_ge_u32 s6, 4
  s_cbranch_scc1 L_f_skip1
  s_lshl_b32 s7, s6, 10
  s_add_u32 s8, s16, s7
  s_addc_u32 s9, s17, 0
  global_load_dwordx4 v[8:11], v2, s[8:9]
  v_lshlrev_b32 v3, 5, v1
  s_lshl_b32 s7, s6, 11
  s_add_u32 s7, s7, 65536
  s_add_u32 s8, s42, s7
  s_addc_u32 s9, s43, 0
  global_load_dwordx4 v[12:15], v3, s[8:9]
  global_load_dwordx4 v[16:19], v3, s[8:9] offset:16
  s_mul_i32 s7, s6, 12288
  s_add_u32 s8, s42, s7
  s_addc_u32 s9, s43, 0
  s_add_u32 s8, s8, 4096
  s_addc_u32 s9, s9, 0
  global_load_dwordx4 v[20:23], v3, s[8:9]
  global_load_dwordx4 v[24:27], v3, s[8:9] offset:16
  global_load_dwordx4 v[28:31], v3, s[8:9] offset:2048
  global_load_dwordx4 v[32:35], v3, s[8:9] offset:2064
  s_add_u32 s8, s8, 4096
  s_addc_u32 s9, s9, 0
  global_load_dwordx4 v[36:39], v3, s[8:9]
  global_load_dwordx4 v[40:43], v3, s[8:9] offset:16
  s_waitcnt vmcnt(4)
  v_lshlrev_b32 v44, 16, v8
  v_and_b32 v45, 0xffff0000, v8
  v_lshlrev_b32 v46, 16, v9
  v_and_b32 v47, 0xffff0000, v9
  v_lshlrev_b32 v48, 16, v10
  v_and_b32 v49, 0xffff0000, v10
  v_lshlrev_b32 v50, 16, v11
  v_and_b32 v51, 0xffff0000, v11
  v_cvt_pk_bf16_f32 v12, v12, v12
  v_lshlrev_b32 v12, 16, v12
  v_mul_f32 v12, v20, v12
  v_cvt_pk_bf16_f32 v12, v12, v12
  v_lshlrev_b32 v12, 16, v12
  v_add_f32 v44, v44, v12
  v_cvt_pk_bf16_f32 v44, v44, v44
  v_lshlrev_b32 v44, 16, v44
  v_cvt_pk_bf16_f32 v13, v13, v13
  v_lshlrev_b32 v13, 16, v13
  v_mul_f32 v13, v21, v13
  v_cvt_pk_bf16_f32 v13, v13, v13
  v_lshlrev_b32 v13, 16, v13
  v_add_f32 v45, v45, v13
  v_cvt_pk_bf16_f32 v45, v45, v45
  v_lshlrev_b32 v45, 16, v45
  v_cvt_pk_bf16_f32 v14, v14, v14
  v_lshlrev_b32 v14, 16, v14
  v_mul_f32 v14, v22, v14
  v_cvt_pk_bf16_f32 v14, v14, v14
  v_lshlrev_b32 v14, 16, v14
  v_add_f32 v46, v46, v14
  v_cvt_pk_bf16_f32 v46, v46, v46
  v_lshlrev_b32 v46, 16, v46
  v_cvt_pk_bf16_f32 v15, v15, v15
  v_lshlrev_b32 v15, 16, v15
  v_mul_f32 v15, v23, v15
  v_cvt_pk_bf16_f32 v15, v15, v15
  v_lshlrev_b32 v15, 16, v15
  v_add_f32 v47, v47, v15
  v_cvt_pk_bf16_f32 v47, v47, v47
  v_lshlrev_b32 v47, 16, v47
  v_cvt_pk_bf16_f32 v16, v16, v16
  v_lshlrev_b32 v16, 16, v16
  v_mul_f32 v16, v24, v16
  v_cvt_pk_bf16_f32 v16, v16, v16
  v_lshlrev_b32 v16, 16, v16
  v_add_f32 v48, v48, v16
  v_cvt_pk_bf16_f32 v48, v48, v48
  v_lshlrev_b32 v48, 16, v48
  v_cvt_pk_bf16_f32 v17, v17, v17
  v_lshlrev_b32 v17, 16, v17
  v_mul_f32 v17, v25, v17
  v_cvt_pk_bf16_f32 v17, v17, v17
  v_lshlrev_b32 v17, 16, v17
  v_add_f32 v49, v49, v17
  v_cvt_pk_bf16_f32 v49, v49, v49
  v_lshlrev_b32 v49, 16, v49
  v_cvt_pk_bf16_f32 v18, v18, v18
  v_lshlrev_b32 v18, 16, v18
  v_mul_f32 v18, v26, v18
  v_cvt_pk_bf16_f32 v18, v18, v18
  v_lshlrev_b32 v18, 16, v18
  v_add_f32 v50, v50, v18
  v_cvt_pk_bf16_f32 v50, v50, v50
  v_lshlrev_b32 v50, 16, v50
  v_cvt_pk_bf16_f32 v19, v19, v19
  v_lshlrev_b32 v19, 16, v19
  v_mul_f32 v19, v27, v19
  v_cvt_pk_bf16_f32 v19, v19, v19
  v_lshlrev_b32 v19, 16, v19
  v_add_f32 v51, v51, v19
  v_cvt_pk_bf16_f32 v51, v51, v51
  v_lshlrev_b32 v51, 16, v51
  s_lshl_b32 s7, s6, 11
  v_add_u32 v3, s7, v3
  ds_write_b128 v3, v[44:47] offset:4096
  ds_write_b128 v3, v[48:51] offset:4112
  v_add_f32 v7, v44, v45
  v_add_f32 v7, v7, v46
  v_add_f32 v7, v7, v47
  v_add_f32 v7, v7, v48
  v_add_f32 v7, v7, v49
  v_add_f32 v7, v7, v50
  v_add_f32 v7, v7, v51
  s_nop 1
  v_add_f32_dpp v7, v7, v7 row_ror:8 row_mask:0xf bank_mask:0xf
  s_nop 1
  v_add_f32_dpp v7, v7, v7 row_ror:4 row_mask:0xf bank_mask:0xf
  s_nop 1
  v_add_f32_dpp v7, v7, v7 row_ror:2 row_mask:0xf bank_mask:0xf
  s_nop 1
  v_add_f32_dpp v7, v7, v7 row_ror:1 row_mask:0xf bank_mask:0xf
  v_mov_b32 v54, v7
  s_nop 1
  v_permlane16_swap_b32 v7, v54
  v_add_f32 v7, v7, v54
  v_mov_b32 v54, v7
  s_nop 1
  v_permlane32_swap_b32 v7, v54
  v_add_f32 v7, v7, v54
  v_mul_f32 v7, 0x3b000000, v7
  v_sub_f32 v54, v44, v7
  v_mul_f32 v52, v54, v54
  v_sub_f32 v54, v45, v7
  v_fmac_f32 v52, v54, v54
  v_sub_f32 v54, v46, v7
  v_fmac_f32 v52, v54, v54
  v_sub_f32 v54, v47, v7
  v_fmac_f32 v52, v54, v54
  v_sub_f32 v54, v48, v7
  v_fmac_f32 v52, v54, v54
  v_sub_f32 v54, v49, v7
  v_fmac_f32 v52, v54, v54
  v_sub_f32 v54, v50, v7
  v_fmac_f32 v52, v54, v54
  v_sub_f32 v54, v51, v7
  v_fmac_f32 v52, v54, v54
  s_nop 1
  v_add_f32_dpp v52, v52, v52 row_ror:8 row_mask:0xf bank_mask:0xf
  s_nop 1
  v_add_f32_dpp v52, v52, v52 row_ror:4 row_mask:0xf bank_mask:0xf
  s_nop 1
  v_add_f32_dpp v52, v52, v52 row_ror:2 row_mask:0xf bank_mask:0xf
  s_nop 1
  v_add_f32_dpp v52, v52, v52 row_ror:1 row_mask:0xf bank_mask:0xf
  v_mov_b32 v54, v52
  s_nop 1
  v_permlane16_swap_b32 v52, v54
  v_add_f32 v52, v52, v54
  v_mov_b32 v54, v52
  s_nop 1
  v_permlane32_swap_b32 v52, v54
  v_add_f32 v52, v52, v54
  v_mul_f32 v52, 0x3b000000, v52
  v_cvt_pk_bf16_f32 v7, v7, v7
  v_lshlrev_b32 v7, 16, v7
  v_cvt_pk_bf16_f32 v52, v52, v52
  v_lshlrev_b32 v52, 16, v52
  v_add_f32 v52, s52, v52
  v_cvt_pk_bf16_f32 v52, v52, v52
  v_lshlrev_b32 v52, 16, v52
  v_sqrt_f32 v52, v52
  s_nop 0
  v_cvt_pk_bf16_f32 v52, v52, v52
  v_lshlrev_b32 v52, 16, v52
  v_rcp_f32 v53, v52
  s_waitcnt vmcnt(0)
  v_sub_f32 v44, v44, v7
  v_cvt_pk_bf16_f32 v44, v44, v44
  v_lshlrev_b32 v44, 16, v44
  v_mul_f32 v54, v44, v53
  v_fma_f32 v55, -v54, v52, v44
  v_fma_f32 v54, v55, v53, v54
  v_cvt_pk_bf16_f32 v44, v54, v54
  v_lshlrev_b32 v44, 16, v44
  v_add_f32 v36, 1.0, v36
  v_cvt_pk_bf16_f32 v36, v36, v36
  v_lshlrev_b32 v36, 16, v36
  v_mul_f32 v44, v44, v36
  v_cvt_pk_bf16_f32 v44, v44, v44
  v_lshlrev_b32 v44, 16, v44
  v_add_f32 v44, v44, v28
  v_sub_f32 v45, v45, v7
  v_cvt_pk_bf16_f32 v45, v45, v45
  v_lshlrev_b32 v45, 16, v45
  v_mul_f32 v54, v45, v53
  v_fma_f32 v55, -v54, v52, v45
  v_fma_f32 v54, v55, v53, v54
  v_cvt_pk_bf16_f32 v45, v54, v54
  v_lshlrev_b32 v45, 16, v45
  v_add_f32 v37, 1.0, v37
  v_cvt_pk_bf16_f32 v37, v37, v37
  v_lshlrev_b32 v37, 16, v37
  v_mul_f32 v45, v45, v37
  v_cvt_pk_bf16_f32 v45, v45, v45
  v_lshlrev_b32 v45, 16, v45
  v_add_f32 v45, v45, v29
  v_sub_f32 v46, v46, v7
  v_cvt_pk_bf16_f32 v46, v46, v46
  v_lshlrev_b32 v46, 16, v46
  v_mul_f32 v54, v46, v53
  v_fma_f32 v55, -v54, v52, v46
  v_fma_f32 v54, v55, v53, v54
  v_cvt_pk_bf16_f32 v46, v54, v54
  v_lshlrev_b32 v46, 16, v46
  v_add_f32 v38, 1.0, v38
  v_cvt_pk_bf16_f32 v38, v38, v38
  v_lshlrev_b32 v38, 16, v38
  v_mul_f32 v46, v46, v38
  v_cvt_pk_bf16_f32 v46, v46, v46
  v_lshlrev_b32 v46, 16, v46
  v_add_f32 v46, v46, v30
  v_sub_f32 v47, v47, v7
  v_cvt_pk_bf16_f32 v47, v47, v47
  v_lshlrev_b32 v47, 16, v47
  v_mul_f32 v54, v47, v53
  v_fma_f32 v55, -v54, v52, v47
  v_fma_f32 v54, v55, v53, v54
  v_cvt_pk_bf16_f32 v47, v54, v54
  v_lshlrev_b32 v47, 16, v47
  v_add_f32 v39, 1.0, v39
  v_cvt_pk_bf16_f32 v39, v39, v39
  v_lshlrev_b32 v39, 16, v39
  v_mul_f32 v47, v47, v39
  v_cvt_pk_bf16_f32 v47, v47, v47
  v_lshlrev_b32 v47, 16, v47
  v_add_f32 v47, v47, v31
  v_sub_f32 v48, v48, v7
  v_cvt_pk_bf16_f32 v48, v48, v48
  v_lshlrev_b32 v48, 16, v48
  v_mul_f32 v54, v48, v53
  v_fma_f32 v55, -v54, v52, v48
  v_fma_f32 v54, v55, v53, v54
  v_cvt_pk_bf16_f32 v48, v54, v54
  v_lshlrev_b32 v48, 16, v48
  v_add_f32 v40, 1.0, v40
  v_cvt_pk_bf16_f32 v40, v40, v40
  v_lshlrev_b32 v40, 16, v40
  v_mul_f32 v48, v48, v40
  v_cvt_pk_bf16_f32 v48, v48, v48
  v_lshlrev_b32 v48, 16, v48
  v_add_f32 v48, v48, v32
  v_sub_f32 v49, v49, v7
  v_cvt_pk_bf16_f32 v49, v49, v49
  v_lshlrev_b32 v49, 16, v49
  v_mul_f32 v54, v49, v53
  v_fma_f32 v55, -v54, v52, v49
  v_fma_f32 v54, v55, v53, v54
  v_cvt_pk_bf16_f32 v49, v54, v54
  v_lshlrev_b32 v49, 16, v49
  v_add_f32 v41, 1.0, v41
  v_cvt_pk_bf16_f32 v41, v41, v41
  v_lshlrev_b32 v41, 16, v41
  v_mul_f32 v49, v49, v41
  v_cvt_pk_bf16_f32 v49, v49, v49
  v_lshlrev_b32 v49, 16, v49
  v_add_f32 v49, v49, v33
  v_sub_f32 v50, v50, v7
  v_cvt_pk_bf16_f32 v50, v50, v50
  v_lshlrev_b32 v50, 16, v50
  v_mul_f32 v54, v50, v53
  v_fma_f32 v55, -v54, v52, v50
  v_fma_f32 v54, v55, v53, v54
  v_cvt_pk_bf16_f32 v50, v54, v54
  v_lshlrev_b32 v50, 16, v50
  v_add_f32 v42, 1.0, v42
  v_cvt_pk_bf16_f32 v42, v42, v42
  v_lshlrev_b32 v42, 16, v42
  v_mul_f32 v50, v50, v42
  v_cvt_pk_bf16_f32 v50, v50, v50
  v_lshlrev_b32 v50, 16, v50
  v_add_f32 v50, v50, v34
  v_sub_f32 v51, v51, v7
  v_cvt_pk_bf16_f32 v51, v51, v51
  v_lshlrev_b32 v51, 16, v51
  v_mul_f32 v54, v51, v53
  v_fma_f32 v55, -v54, v52, v51
  v_fma_f32 v54, v55, v53, v54
  v_cvt_pk_bf16_f32 v51, v54, v54
  v_lshlrev_b32 v51, 16, v51
  v_add_f32 v43, 1.0, v43
  v_cvt_pk_bf16_f32 v43, v43, v43
  v_lshlrev_b32 v43, 16, v43
  v_mul_f32 v51, v51, v43
  v_cvt_pk_bf16_f32 v51, v51, v51
  v_lshlrev_b32 v51, 16, v51
  v_add_f32 v51, v51, v35
  v_cvt_pk_bf16_f32 v8, v44, v45
  v_cvt_pk_bf16_f32 v9, v46, v47
  v_cvt_pk_bf16_f32 v10, v48, v49
  v_cvt_pk_bf16_f32 v11, v50, v51
  s_lshl_b32 s7, s6, 10
  v_add_u32 v3, s7, v2
  ds_write_b128 v3, v[8:11] offset:0
L_f_skip1:
  s_nop 7
  v_lshrrev_b32 v3, 2, v1
  v_lshlrev_b32 v3, 7, v3
  v_and_b32 v4, 3, v1
  v_lshlrev_b32 v4, 4, v4
  v_add_u32 v3, v3, v4
  s_lshl_b32 s7, s6, 12
  s_add_u32 s7, s7, 16384
  v_add_u32 v3, s7, v3
  s_waitcnt vmcnt(5)
  ds_write_b128 v3, v[64:67] offset:0
  s_waitcnt vmcnt(4)
  ds_write_b128 v3, v[72:75] offset:64
  s_waitcnt vmcnt(3)
  ds_write_b128 v3, v[68:71] offset:2048
  s_waitcnt vmcnt(2)
  ds_write_b128 v3, v[76:79] offset:2112
  s_lshl_b32 s7, s6, 11
  v_add_u32 v3, s7, v2
  v_add_u32 v3, 81920, v3
  s_waitcnt vmcnt(1)
  ds_write_b128 v3, v[80:83]
  s_waitcnt vmcnt(0)
  ds_write_b128 v3, v[84:87] offset:1024
  s_waitcnt vmcnt(0)
  s_waitcnt lgkmcnt(0)
  s_barrier
  s_cmp_ge_u32 s6, 2
  s_cbranch_scc1 L_f_skip2
  v_and_b32 v3, 15, v1
  v_lshlrev_b32 v4, 10, v3
  v_lshrrev_b32 v5, 4, v1
  v_lshlrev_b32 v6, 4, v5
  v_add_u32 v4, v4, v6
  v_lshlrev_b32 v6, 3, v5
  v_lshrrev_b32 v7, 2, v3
  v_add_u32 v6, v6, v7
  v_lshlrev_b32 v6, 7, v6
  v_and_b32 v7, 3, v3
  v_lshlrev_b32 v7, 3, v7
  v_add_u32 v6, v6, v7
  s_lshl_b32 s7, s6, 5
  s_add_u32 s7, s7, 16384
  v_add_u32 v6, s7, v6
  v_mov_b32 v8, 0
  v_mov_b32 v9, 0
  v_mov_b32 v10, 0
  v_mov_b32 v11, 0
  v_mov_b32 v12, 0
  v_mov_b32 v13, 0
  v_mov_b32 v14, 0
  v_mov_b32 v15, 0
  v_mov_b32 v24, 0
  v_mov_b32 v25, 0
  v_mov_b32 v26, 0
  v_mov_b32 v27, 0
  v_mov_b32 v28, 0
  v_mov_b32 v29, 0
  v_mov_b32 v30, 0
  v_mov_b32 v31, 0
  s_mov_b32 s10, 0x000f000f
  s_mov_b32 s11, 0x000f000f
  s_mov_b64 exec, s[10:11]
  ds_read_b128 v[8:11], v4 offset:0
  s_mov_b64 exec, -1
  ds_read_b64_tr_b16 v[32:33], v6 offset:0
  ds_read_b64_tr_b16 v[34:35], v6 offset:512
  ds_read_b64_tr_b16 v[36:37], v6 offset:64
  ds_read_b64_tr_b16 v[38:39], v6 offset:576
  s_waitcnt lgkmcnt(2)
  v_mfma_f32_16x16x32_bf16 v[24:27], v[8:11], v[32:35], v[24:27]
  s_waitcnt lgkmcnt(0)
  v_mfma_f32_16x16x32_bf16 v[28:31], v[8:11], v[36:39], v[28:31]
  s_mov_b64 exec, s[10:11]
  ds_read_b128 v[12:15], v4 offset:64
  s_mov_b64 exec, -1
  ds_read_b64_tr_b16 v[40:41], v6 offset:4096
  ds_read_b64_tr_b16 v[42:43], v6 offset:4608
  ds_read_b64_tr_b16 v[44:45], v6 offset:4160
  ds_read_b64_tr_b16 v[46:47], v6 offset:4672
  s_waitcnt lgkmcnt(2)
  v_mfma_f32_16x16x32_bf16 v[24:27], v[12:15], v[40:43], v[24:27]
  s_waitcnt lgkmcnt(0)
  v_mfma_f32_16x16x32_bf16 v[28:31], v[12:15], v[44:47], v[28:31]
  s_mov_b64 exec, s[10:11]
  ds_read_b128 v[8:11], v4 offset:128
  s_mov_b64 exec, -1
  ds_read_b64_tr_b16 v[32:33], v6 offset:8192
  ds_read_b64_tr_b16 v[34:35], v6 offset:8704
  ds_read_b64_tr_b16 v[36:37], v6 offset:8256
  ds_read_b64_tr_b16 v[38:39], v6 offset:8768
  s_waitcnt lgkmcnt(2)
  v_mfma_f32_16x16x32_bf16 v[24:27], v[8:11], v[32:35], v[24:27]
  s_waitcnt lgkmcnt(0)
  v_mfma_f32_16x16x32_bf16 v[28:31], v[8:11], v[36:39], v[28:31]
  s_mov_b64 exec, s[10:11]
  ds_read_b128 v[12:15], v4 offset:192
  s_mov_b64 exec, -1
  ds_read_b64_tr_b16 v[40:41], v6 offset:12288
  ds_read_b64_tr_b16 v[42:43], v6 offset:12800
  ds_read_b64_tr_b16 v[44:45], v6 offset:12352
  ds_read_b64_tr_b16 v[46:47], v6 offset:12864
  s_waitcnt lgkmcnt(2)
  v_mfma_f32_16x16x32_bf16 v[24:27], v[12:15], v[40:43], v[24:27]
  s_waitcnt lgkmcnt(0)
  v_mfma_f32_16x16x32_bf16 v[28:31], v[12:15], v[44:47], v[28:31]
  s_mov_b64 exec, s[10:11]
  ds_read_b128 v[8:11], v4 offset:256
  s_mov_b64 exec, -1
  ds_read_b64_tr_b16 v[32:33], v6 offset:16384
  ds_read_b64_tr_b16 v[34:35], v6 offset:16896
  ds_read_b64_tr_b16 v[36:37], v6 offset:16448
  ds_read_b64_tr_b16 v[38:39], v6 offset:16960
  s_waitcnt lgkmcnt(2)
  v_mfma_f32_16x16x32_bf16 v[24:27], v[8:11], v[32:35], v[24:27]
  s_waitcnt lgkmcnt(0)
  v_mfma_f32_16x16x32_bf16 v[28:31], v[8:11], v[36:39], v[28:31]
  s_mov_b64 exec, s[10:11]
  ds_read_b128 v[12:15], v4 offset:320
  s_mov_b64 exec, -1
  ds_read_b64_tr_b16 v[40:41], v6 offset:20480
  ds_read_b64_tr_b16 v[42:43], v6 offset:20992
  ds_read_b64_tr_b16 v[44:45], v6 offset:20544
  ds_read_b64_tr_b16 v[46:47], v6 offset:21056
  s_waitcnt lgkmcnt(2)
  v_mfma_f32_16x16x32_bf16 v[24:27], v[12:15], v[40:43], v[24:27]
  s_waitcnt lgkmcnt(0)
  v_mfma_f32_16x16x32_bf16 v[28:31], v[12:15], v[44:47], v[28:31]
  s_mov_b64 exec, s[10:11]
  ds_read_b128 v[8:11], v4 offset:384
  s_mov_b64 exec, -1
  ds_read_b64_tr_b16 v[32:33], v6 offset:24576
  ds_read_b64_tr_b16 v[34:35], v6 offset:25088
  ds_read_b64_tr_b16 v[36:37], v6 offset:24640
  ds_read_b64_tr_b16 v[38:39], v6 offset:25152
  s_waitcnt lgkmcnt(2)
  v_mfma_f32_16x16x32_bf16 v[24:27], v[8:11], v[32:35], v[24:27]
  s_waitcnt lgkmcnt(0)
  v_mfma_f32_16x16x32_bf16 v[28:31], v[8:11], v[36:39], v[28:31]
  s_mov_b64 exec, s[10:11]
  ds_read_b128 v[12:15], v4 offset:448
  s_mov_b64 exec, -1
  ds_read_b64_tr_b16 v[40:41], v6 offset:28672
  ds_read_b64_tr_b16 v[42:43], v6 offset:29184
  ds_read_b64_tr_b16 v[44:45], v6 offset:28736
  ds_read_b64_tr_b16 v[46:47], v6 offset:29248
  s_waitcnt lgkmcnt(2)
  v_mfma_f32_16x16x32_bf16 v[24:27], v[12:15], v[40:43], v[24:27]
  s_waitcnt lgkmcnt(0)
  v_mfma_f32_16x16x32_bf16 v[28:31], v[12:15], v[44:47], v[28:31]
  s_mov_b64 exec, s[10:11]
  ds_read_b128 v[8:11], v4 offset:512
  s_mov_b64 exec, -1
  ds_read_b64_tr_b16 v[32:33], v6 offset:32768
  ds_read_b64_tr_b16 v[34:35], v6 offset:33280
  ds_read_b64_tr_b16 v[36:37], v6 offset:32832
  ds_read_b64_tr_b16 v[38:39], v6 offset:33344
  s_waitcnt lgkmcnt(2)
  v_mfma_f32_16x16x32_bf16 v[24:27], v[8:11], v[32:35], v[24:27]
  s_waitcnt lgkmcnt(0)
  v_mfma_f32_16x16x32_bf16 v[28:31], v[8:11], v[36:39], v[28:31]
  s_mov_b64 exec, s[10:11]
  ds_read_b128 v[12:15], v4 offset:576
  s_mov_b64 exec, -1
  ds_read_b64_tr_b16 v[40:41], v6 offset:36864
  ds_read_b64_tr_b16 v[42:43], v6 offset:37376
  ds_read_b64_tr_b16 v[44:45], v6 offset:36928
  ds_read_b64_tr_b16 v[46:47], v6 offset:37440
  s_waitcnt lgkmcnt(2)
  v_mfma_f32_16x16x32_bf16 v[24:27], v[12:15], v[40:43], v[24:27]
  s_waitcnt lgkmcnt(0)
  v_mfma_f32_16x16x32_bf16 v[28:31], v[12:15], v[44:47], v[28:31]
  s_mov_b64 exec, s[10:11]
  ds_read_b128 v[8:11], v4 offset:640
  s_mov_b64 exec, -1
  ds_read_b64_tr_b16 v[32:33], v6 offset:40960
  ds_read_b64_tr_b16 v[34:35], v6 offset:41472
  ds_read_b64_tr_b16 v[36:37], v6 offset:41024
  ds_read_b64_tr_b16 v[38:39], v6 offset:41536
  s_waitcnt lgkmcnt(2)
  v_mfma_f32_16x16x32_bf16 v[24:27], v[8:11], v[32:35], v[24:27]
  s_waitcnt lgkmcnt(0)
  v_mfma_f32_16x16x32_bf16 v[28:31], v[8:11], v[36:39], v[28:31]
  s_mov_b64 exec, s[10:11]
  ds_read_b128 v[12:15], v4 offset:704
  s_mov_b64 exec, -1
  ds_read_b64_tr_b16 v[40:41], v6 offset:45056
  ds_read_b64_tr_b16 v[42:43], v6 offset:45568
  ds_read_b64_tr_b16 v[44:45], v6 offset:45120
  ds_read_b64_tr_b16 v[46:47], v6 offset:45632
  s_waitcnt lgkmcnt(2)
  v_mfma_f32_16x16x32_bf16 v[24:27], v[12:15], v[40:43], v[24:27]
  s_waitcnt lgkmcnt(0)
  v_mfma_f32_16x16x32_bf16 v[28:31], v[12:15], v[44:47], v[28:31]
  s_mov_b64 exec, s[10:11]
  ds_read_b128 v[8:11], v4 offset:768
  s_mov_b64 exec, -1
  ds_read_b64_tr_b16 v[32:33], v6 offset:49152
  ds_read_b64_tr_b16 v[34:35], v6 offset:49664
  ds_read_b64_tr_b16 v[36:37], v6 offset:49216
  ds_read_b64_tr_b16 v[38:39], v6 offset:49728
  s_waitcnt lgkmcnt(2)
  v_mfma_f32_16x16x32_bf16 v[24:27], v[8:11], v[32:35], v[24:27]
  s_waitcnt lgkmcnt(0)
  v_mfma_f32_16x16x32_bf16 v[28:31], v[8:11], v[36:39], v[28:31]
  s_mov_b64 exec, s[10:11]
  ds_read_b128 v[12:15], v4 offset:832
  s_mov_b64 exec, -1
  ds_read_b64_tr_b16 v[40:41], v6 offset:53248
  ds_read_b64_tr_b16 v[42:43], v6 offset:53760
  ds_read_b64_tr_b16 v[44:45], v6 offset:53312
  ds_read_b64_tr_b16 v[46:47], v6 offset:53824
  s_waitcnt lgkmcnt(2)
  v_mfma_f32_16x16x32_bf16 v[24:27], v[12:15], v[40:43], v[24:27]
  s_waitcnt lgkmcnt(0)
  v_mfma_f32_16x16x32_bf16 v[28:31], v[12:15], v[44:47], v[28:31]
  s_mov_b64 exec, s[10:11]
  ds_read_b128 v[8:11], v4 offset:896
  s_mov_b64 exec, -1
  ds_read_b64_tr_b16 v[32:33], v6 offset:57344
  ds_read_b64_tr_b16 v[34:35], v6 offset:57856
  ds_read_b64_tr_b16 v[36:37], v6 offset:57408
  ds_read_b64_tr_b16 v[38:39], v6 offset:57920
  s_waitcnt lgkmcnt(2)
  v_mfma_f32_16x16x32_bf16 v[24:27], v[8:11], v[32:35], v[24:27]
  s_waitcnt lgkmcnt(0)
  v_mfma_f32_16x16x32_bf16 v[28:31], v[8:11], v[36:39], v[28:31]
  s_mov_b64 exec, s[10:11]
  ds_read_b128 v[12:15], v4 offset:960
  s_mov_b64 exec, -1
  ds_read_b64_tr_b16 v[40:41], v6 offset:61440
  ds_read_b64_tr_b16 v[42:43], v6 offset:61952
  ds_read_b64_tr_b16 v[44:45], v6 offset:61504
  ds_read_b64_tr_b16 v[46:47], v6 offset:62016
  s_waitcnt lgkmcnt(2)
  v_mfma_f32_16x16x32_bf16 v[24:27], v[12:15], v[40:43], v[24:27]
  s_waitcnt lgkmcnt(0)
  v_mfma_f32_16x16x32_bf16 v[28:31], v[12:15], v[44:47], v[28:31]
  s_mov_b32 s12, 0x3f4c422a
  s_mov_b32 s13, 0x3d372713
  s_nop 3
  v_cvt_pk_bf16_f32 v24, v24, v24
  v_lshlrev_b32 v24, 16, v24
  v_cvt_pk_bf16_f32 v28, v28, v28
  v_lshlrev_b32 v28, 16, v28
  v_mul_f32 v48, v24, v24
  v_mul_f32 v48, v48, v24
  v_mul_f32 v48, s13, v48
  v_add_f32 v48, v24, v48
  v_mul_f32 v48, s12, v48
  v_add_f32 v48, v48, v48
  v_mul_f32 v48, s50, v48
  v_exp_f32 v48, v48
  s_nop 0
  v_add_f32 v48, 1.0, v48
  v_rcp_f32 v48, v48
  s_nop 0
  v_add_f32 v48, v48, v48
  v_sub_f32 v48, 1.0, v48
  v_add_f32 v48, 1.0, v48
  v_mul_f32 v49, 0.5, v24
  v_mul_f32 v48, v49, v48
  v_cvt_pk_bf16_f32 v48, v48, v48
  v_lshlrev_b32 v48, 16, v48
  v_mul_f32 v48, v48, v28
  v_cvt_pk_bf16_f32 v50, v48, 0
  v_cvt_pk_bf16_f32 v25, v25, v25
  v_lshlrev_b32 v25, 16, v25
  v_cvt_pk_bf16_f32 v29, v29, v29
  v_lshlrev_b32 v29, 16, v29
  v_mul_f32 v48, v25, v25
  v_mul_f32 v48, v48, v25
  v_mul_f32 v48, s13, v48
  v_add_f32 v48, v25, v48
  v_mul_f32 v48, s12, v48
  v_add_f32 v48, v48, v48
  v_mul_f32 v48, s50, v48
  v_exp_f32 v48, v48
  s_nop 0
  v_add_f32 v48, 1.0, v48
  v_rcp_f32 v48, v48
  s_nop 0
  v_add_f32 v48, v48, v48
  v_sub_f32 v48, 1.0, v48
  v_add_f32 v48, 1.0, v48
  v_mul_f32 v49, 0.5, v25
  v_mul_f32 v48, v49, v48
  v_cvt_pk_bf16_f32 v48, v48, v48
  v_lshlrev_b32 v48, 16, v48
  v_mul_f32 v48, v48, v29
  v_cvt_pk_bf16_f32 v51, v48, 0
  v_cvt_pk_bf16_f32 v26, v26, v26
  v_lshlrev_b32 v26, 16, v26
  v_cvt_pk_bf16_f32 v30, v30, v30
  v_lshlrev_b32 v30, 16, v30
  v_mul_f32 v48, v26, v26
  v_mul_f32 v48, v48, v26
  v_mul_f32 v48, s13, v48
  v_add_f32 v48, v26, v48
  v_mul_f32 v48, s12, v48
  v_add_f32 v48, v48, v48
  v_mul_f32 v48, s50, v48
  v_exp_f32 v48, v48
  s_nop 0
  v_add_f32 v48, 1.0, v48
  v_rcp_f32 v48, v48
  s_nop 0
  v_add_f32 v48, v48, v48
  v_sub_f32 v48, 1.0, v48
  v_add_f32 v48, 1.0, v48
  v_mul_f32 v49, 0.5, v26
  v_mul_f32 v48, v49, v48
  v_cvt_pk_bf16_f32 v48, v48, v48
  v_lshlrev_b32 v48, 16, v48
  v_mul_f32 v48, v48, v30
  v_cvt_pk_bf16_f32 v52, v48, 0
  v_cvt_pk_bf16_f32 v27, v27, v27
  v_lshlrev_b32 v27, 16, v27
  v_cvt_pk_bf16_f32 v31, v31, v31
  v_lshlrev_b32 v31, 16, v31
  v_mul_f32 v48, v27, v27
  v_mul_f32 v48, v48, v27
  v_mul_f32 v48, s13, v48
  v_add_f32 v48, v27, v48
  v_mul_f32 v48, s12, v48
  v_add_f32 v48, v48, v48
  v_mul_f32 v48, s50, v48
  v_exp_f32 v48, v48
  s_nop 0
  v_add_f32 v48, 1.0, v48
  v_rcp_f32 v48, v48
  s_nop 0
  v_add_f32 v48, v48, v48
  v_sub_f32 v48, 1.0, v48
  v_add_f32 v48, 1.0, v48
  v_mul_f32 v49, 0.5, v27
  v_mul_f32 v48, v49, v48
  v_cvt_pk_bf16_f32 v48, v48, v48
  v_lshlrev_b32 v48, 16, v48
  v_mul_f32 v48, v48, v31
  v_cvt_pk_bf16_f32 v53, v48, 0
  v_lshlrev_b32 v48, 1, v3
  s_lshl_b32 s7, s6, 5
  v_add_u32 v48, s7, v48
  s_mov_b64 exec, 0xffff
  ds_write_b16 v48, v50 offset:12288
  ds_write_b16 v48, v51 offset:12352
  ds_write_b16 v48, v52 offset:12416
  ds_write_b16 v48, v53 offset:12480
  s_mov_b64 exec, -1
L_f_skip2:
  s_nop 7
  s_waitcnt lgkmcnt(0)
  s_barrier
  v_and_b32 v3, 15, v1
  v_lshrrev_b32 v5, 4, v1
  v_lshlrev_b32 v4, 6, v3
  v_lshlrev_b32 v6, 4, v5
  v_add_u32 v4, v4, v6
  v_lshlrev_b32 v6, 3, v5
  v_lshrrev_b32 v7, 2, v3
  v_add_u32 v6, v6, v7
  v_lshlrev_b32 v6, 10, v6
  v_and_b32 v7, 3, v3
  v_lshlrev_b32 v7, 3, v7
  v_add_u32 v6, v6, v7
  s_lshl_b32 s7, s6, 6
  s_add_u32 s7, s7, 81920
  v_add_u32 v6, s7, v6
  v_mov_b32 v8, 0
  v_mov_b32 v9, 0
  v_mov_b32 v10, 0
  v_mov_b32 v11, 0
  v_mov_b32 v24, 0
  v_mov_b32 v25, 0
  v_mov_b32 v26, 0
  v_mov_b32 v27, 0
  v_mov_b32 v28, 0
  v_mov_b32 v29, 0
  v_mov_b32 v30, 0
  v_mov_b32 v31, 0
  s_mov_b32 s10, 0x000f000f
  s_mov_b32 s11, 0x000f000f
  s_mov_b64 exec, s[10:11]
  ds_read_b128 v[8:11], v4 offset:12288
  s_mov_b64 exec, -1
  ds_read_b64_tr_b16 v[32:33], v6 offset:0
  ds_read_b64_tr_b16 v[34:35], v6 offset:4096
  ds_read_b64_tr_b16 v[36:37], v6 offset:32
  ds_read_b64_tr_b16 v[38:39], v6 offset:4128
  s_waitcnt lgkmcnt(2)
  v_mfma_f32_16x16x32_bf16 v[24:27], v[8:11], v[32:35], v[24:27]
  s_waitcnt lgkmcnt(0)
  v_mfma_f32_16x16x32_bf16 v[28:31], v[8:11], v[36:39], v[28:31]
  v_lshlrev_b32 v48, 2, v3
  s_lshl_b32 s7, s6, 7
  s_add_u32 s7, s7, 73728
  s_add_u32 s8, s42, s7
  s_addc_u32 s9, s43, 0
  s_add_u32 s14, s8, 4096
  s_addc_u32 s15, s9, 0
  s_mov_b64 exec, 0xffff
  global_atomic_add_f32 v48, v24, s[8:9] offset:0
  global_atomic_add_f32 v48, v25, s[8:9] offset:2048
  global_atomic_add_f32 v48, v26, s[14:15] offset:0
  global_atomic_add_f32 v48, v27, s[14:15] offset:2048
  global_atomic_add_f32 v48, v28, s[8:9] offset:64
  global_atomic_add_f32 v48, v29, s[8:9] offset:2112
  global_atomic_add_f32 v48, v30, s[14:15] offset:64
  global_atomic_add_f32 v48, v31, s[14:15] offset:2112
  s_mov_b64 exec, -1
  s_waitcnt vmcnt(0)
  s_barrier
  s_cmp_lg_u32 s6, 0
  s_cbranch_scc1 L_f_arr
  v_mov_b32 v48, 0
  v_mov_b32 v49, 1
  s_mov_b64 exec, 1
  global_atomic_add v50, v48, v49, s[40:41] sc0 sc1
  s_waitcnt vmcnt(0)
  ds_write_b32 v48, v50 offset:12544
  s_mov_b64 exec, -1
L_f_arr:
  s_nop 7
  s_waitcnt lgkmcnt(0)
  s_barrier
  v_mov_b32 v48, 0
  ds_read_b32 v50, v48 offset:12544
  s_waitcnt lgkmcnt(0)
  v_readfirstlane_b32 s7, v50
  s_cmp_lg_u32 s7, 55
  s_cbranch_scc1 L_ffn_end
  v_lshlrev_b32 v48, 3, v0
  s_add_u32 s8, s42, 73728
  s_addc_u32 s9, s43, 0
  global_load_dwordx2 v[50:51], v48, s[8:9] sc1
  v_lshrrev_b32 v52, 8, v0
  v_mul_u32_u24 v53, 12288, v52
  v_and_b32 v54, 255, v0
  v_lshlrev_b32 v54, 3, v54
  v_add_u32 v53, v53, v54
  v_add_u32 v53, 10240, v53
  global_load_dwordx2 v[56:57], v53, s[42:43]
  ds_read_b64 v[58:59], v48 offset:4096
  s_waitcnt vmcnt(0)
  s_waitcnt lgkmcnt(0)
  v_cvt_pk_bf16_f32 v50, v50, v50
  v_lshlrev_b32 v50, 16, v50
  v_mul_f32 v50, v56, v50
  v_cvt_pk_bf16_f32 v50, v50, v50
  v_lshlrev_b32 v50, 16, v50
  v_add_f32 v50, v58, v50
  v_cvt_pk_bf16_f32 v51, v51, v51
  v_lshlrev_b32 v51, 16, v51
  v_mul_f32 v51, v57, v51
  v_cvt_pk_bf16_f32 v51, v51, v51
  v_lshlrev_b32 v51, 16, v51
  v_add_f32 v51, v59, v51
  v_cvt_pk_bf16_f32 v50, v50, v51
  v_lshlrev_b32 v48, 2, v0
  global_store_dword v48, v50, s[38:39]
L_ffn_end:
  s_nop 7
  s_endpgm
.section .rodata,"a"
.p2align 6
.amdhsa_kernel adaln_att_kernel
  .amdhsa_next_free_vgpr 120
  .amdhsa_next_free_sgpr 96
  .amdhsa_accum_offset 120
  .amdhsa_group_segment_fixed_size 0
  .amdhsa_kernarg_size 112
  .amdhsa_user_sgpr_count 2
  .amdhsa_user_sgpr_kernarg_segment_ptr 1
  .amdhsa_system_sgpr_workgroup_id_x 1
.end_amdhsa_kernel
.amdhsa_kernel adaln_ffn_kernel
  .amdhsa_next_free_vgpr 96
  .amdhsa_next_free_sgpr 96
  .amdhsa_accum_offset 96
  .amdhsa_group_segment_fixed_size 0
  .amdhsa_kernarg_size 112
  .amdhsa_user_sgpr_count 2
  .amdhsa_user_sgpr_kernarg_segment_ptr 1
  .amdhsa_system_sgpr_workgroup_id_x 1
.end_amdhsa_kernel
```
